```python
import torch

def _softmax(x, axis=-1):
    return torch.softmax(x, dim=axis)
def _gelu(x):
    return torch.nn.functional.gelu(x, approximate="tanh")
def _silu(x):
    return torch.nn.functional.silu(x)
def _sigmoid(x):
    return torch.sigmoid(x)
def _layernorm(x, axis=-1, eps=1e-5):
    m = x.mean(dim=axis, keepdim=True)
    v = x.var(dim=axis, keepdim=True, unbiased=False)
    return (x - m) / torch.sqrt(v + eps)
def _scatter_add(tgt, idx, src, axis=0):
    return tgt.clone().index_add_(axis, idx, src)
def _segment_sum(src, seg, n):
    out = torch.zeros((n,) + src.shape[1:], dtype=src.dtype)
    return out.index_add_(0, seg, src)
def _pad(x, pw):
    flat = tuple(v for pair in reversed(pw) for v in pair)
    return torch.nn.functional.pad(x, flat)

kernel_name = 'gated_mix__spectral_fnet__sliding_local_dilated__prompt'

def setup_inputs():

    _w = (lambda a: (lambda t: t.to(torch.bfloat16) if t.is_floating_point() else t)(torch.as_tensor(a)))
    def _A_setup():
        B, S, D = 1, 2048, 640
        ns = torch.arange(S)[:, None] * torch.arange(S)[None, :]
        nd = torch.arange(D)[:, None] * torch.arange(D)[None, :]
        Ws_re = torch.cos(-2.0 * torch.pi * ns / S).to(float)
        Ws_im = torch.sin(-2.0 * torch.pi * ns / S).to(float)
        Wd_re = torch.cos(-2.0 * torch.pi * nd / D).to(float)
        Wd_im = torch.sin(-2.0 * torch.pi * nd / D).to(float)
        return {
            "x": _w((lambda *s: torch.randn(*s, dtype=torch.bfloat16) * 0.05)(B, S, D)),
            "dft_seq_re": _w(Ws_re),
            "dft_seq_im": _w(Ws_im),
            "dft_hid_re": _w(Wd_re),
            "dft_hid_im": _w(Wd_im),
        }
    _A_in = _A_setup()

    def _B_setup():
        B, S, D = 1, 2048, 640
        return {
            "x": _w((lambda *s: torch.randn(*s, dtype=torch.bfloat16) * 0.05)(B, S, D)),
            "wqkv": _w((lambda *s: torch.randn(*s, dtype=torch.bfloat16) * 1.6)(D, 3 * D)),
            "wo": _w((lambda *s: torch.randn(*s, dtype=torch.bfloat16) * 0.2)(D, D)),
        }
    _B_in = _B_setup()

    return {
        "A_x": _A_in["x"],
        "A_dft_seq_re": _A_in["dft_seq_re"],
        "A_dft_seq_im": _A_in["dft_seq_im"],
        "A_dft_hid_re": _A_in["dft_hid_re"],
        "A_dft_hid_im": _A_in["dft_hid_im"],
        "B_x": _B_in["x"],
        "B_wqkv": _B_in["wqkv"],
        "B_wo": _B_in["wo"],
        "gate_w": _w((lambda *s: torch.randn(*s, dtype=torch.bfloat16) * 0.05)(640) * 16.0),
    }

def reference(A_x, A_dft_seq_re, A_dft_seq_im, A_dft_hid_re, A_dft_hid_im, B_x, B_wqkv, B_wo, gate_w):
    def _A_ref(x, dft_seq_re, dft_seq_im, dft_hid_re, dft_hid_im):
        a = torch.einsum("bsd,ed->bse", x, dft_hid_re)
        b = torch.einsum("bsd,ed->bse", x, dft_hid_im)
        y = torch.einsum("ts,bse->bte", dft_seq_re, a) - torch.einsum("ts,bse->bte", dft_seq_im, b)
        return y

    def _B_ref(x, wqkv, wo):
        B, S, D = x.shape
        H = 32; Dh = D // H
        W, dil = 8, 2
        qkv = (lambda x, *d: x.permute(*d))((x @ wqkv).reshape(B, S, 3, H, Dh), 2, 0, 3, 1, 4)
        q, k, v = qkv[0], qkv[1], qkv[2]
        scale = Dh ** -0.5
        pos = torch.arange(S)
        off = torch.arange(W) * dil
        idx = pos[:, None] - off[None, :]
        mask = idx >= 0
        idx_c = torch.where(mask, idx, 0).reshape(-1)
        kg = k[:, :, idx_c, :].reshape(B, H, S, W, Dh)
        vg = v[:, :, idx_c, :].reshape(B, H, S, W, Dh)
        logits = torch.einsum("bhsd,bhswd->bhsw", q, kg) * scale
        logits = torch.where(mask[None, None, :, :], logits, -1e9)
        attn = _softmax(logits, axis=-1)
        o = torch.einsum("bhsw,bhswd->bhsd", attn, vg)
        return (lambda x, *d: x.permute(*d))(o, 0, 2, 1, 3).reshape(B, S, D) @ wo

    x = A_x
    g = _sigmoid((x * gate_w).sum(-1, keepdims=True))
    a = _A_ref(x, A_dft_seq_re, A_dft_seq_im, A_dft_hid_re, A_dft_hid_im)
    b = _B_ref(x, B_wqkv, B_wo)
    return g * a + (1 - g) * b
```

```asm
; @launch grid=(256,1,1) block=(512,1,1) lds=163840
.amdgcn_target "amdgcn-amd-amdhsa--gfx950"
.text
.globl gated_mix__spectral_fnet__sliding_local_dilated__prompt_kernel
.p2align 8
.type gated_mix__spectral_fnet__sliding_local_dilated__prompt_kernel,@function
gated_mix__spectral_fnet__sliding_local_dilated__prompt_kernel:
    s_cmp_ge_u32 s2, 256
    s_cbranch_scc1 L_END
    s_load_dwordx16 s[4:19], s[0:1], 0
    s_load_dwordx8 s[20:27], s[0:1], 64
    s_getpc_b64 s[28:29]
L_PC:
    v_lshlrev_b32 v255, 7, v0
    v_cmp_gt_u32 vcc, L_END-L_PC, v255
    s_nop 0
    s_and_saveexec_b64 s[30:31], vcc
    s_cbranch_execz L_NOCPF
    global_load_dword v255, v255, s[28:29]
L_NOCPF:
    s_mov_b64 exec, -1
    v_lshrrev_b32 v1, 6, v0
    v_and_b32 v0, 63, v0
    v_readfirstlane_b32 s3, v1
    s_and_b32 s48, s2, 1
    s_lshr_b32 s49, s2, 1
    s_and_b32 s49, s49, 3
    s_lshr_b32 s50, s2, 3
    s_and_b32 s51, s3, 3
    s_and_b32 s52, s50, 7
    s_lshr_b32 s70, s50, 4
    s_lshl_b32 s70, s70, 1
    s_lshl_b32 s53, s49, 2
    s_add_u32 s53, s53, s70
    s_add_u32 s53, s53, s48
    s_sub_u32 s70, 32, s53
    s_cmp_eq_u32 s53, 0
    s_cselect_b32 s70, 16, s70
    s_bitcmp1_b32 s50, 3
    s_cselect_b32 s53, s70, s53
    s_sub_u32 s54, 32, s53
    s_and_b32 s54, s54, 31
    s_cmp_lt_u32 s52, 4
    s_cselect_b32 s54, s53, s54
    s_mul_i32 s55, s48, 0
    s_add_u32 s55, s55, s49
    s_mul_i32 s55, s55, 0
    s_sub_u32 s70, s55, 5
    s_min_u32 s55, s55, s70
    s_cmp_ge_u32 s50, 24
    s_cbranch_scc1 L_DFT
    s_cmp_ge_u32 s50, 20
    s_cbranch_scc1 L_AUX
    s_cmp_ge_u32 s3, 4
    s_cbranch_scc0 L_QCOMP
    s_lshl_b32 s56, s49, 1
    s_and_b32 s70, s50, 1
    s_add_u32 s56, s56, s70
    s_lshr_b32 s57, s50, 1
    s_mul_i32 s58, s57, 102
    s_lshl_b32 s78, s58, 1
    s_add_u32 s78, s78, s48
    s_mul_i32 s78, s78, 1280
    s_mul_i32 s79, s56, 160
    s_lshr_b32 s59, s51, 1
    s_lshl_b32 s59, s59, 2
    s_and_b32 s70, s51, 1
    s_add_u32 s59, s59, s70
    s_mul_i32 s59, s59, 15360
    s_add_u32 s79, s79, s59
    s_mov_b32 s81, s55
    s_lshl_b32 s66, s81, 7
    s_add_u32 s66, s66, s78
    s_mul_i32 s67, s81, 245760
    s_add_u32 s67, s67, s79
    s_add_u32 s68, s67, 122880
    s_mul_i32 s76, s51, 3584
    s_lshl_b32 s77, s51, 12
    s_add_u32 s77, s77, 14336
    s_mul_i32 s59, s51, 28
    v_lshrrev_b32 v100, 3, v0
    v_add_u32 v100, s59, v100
    v_and_b32 v101, 7, v0
    v_add_u32 v102, 0, v100
    v_mul_u32_u24 v82, 2560, v102
    v_bfe_u32 v102, v102, 1, 3
    v_xor_b32 v102, v102, v101
    v_lshl_add_u32 v82, v102, 4, v82
    v_add_u32 v102, 8, v100
    v_mul_u32_u24 v83, 2560, v102
    v_bfe_u32 v102, v102, 1, 3
    v_xor_b32 v102, v102, v101
    v_lshl_add_u32 v83, v102, 4, v83
    v_subrev_u32 v83, 1024, v83
    v_add_u32 v102, 16, v100
    v_mul_u32_u24 v84, 2560, v102
    v_bfe_u32 v102, v102, 1, 3
    v_xor_b32 v102, v102, v101
    v_lshl_add_u32 v84, v102, 4, v84
    v_subrev_u32 v84, 2048, v84
    v_add_u32 v102, 24, v100
    v_mul_u32_u24 v85, 2560, v102
    v_bfe_u32 v102, v102, 1, 3
    v_xor_b32 v102, v102, v101
    v_lshl_add_u32 v85, v102, 4, v85
    v_subrev_u32 v85, 3072, v85
    s_and_b32 s70, s56, 3
    s_lshl_b32 s70, s70, 1
    s_sub_u32 s60, 8, s70
    s_add_u32 s61, s70, 2
    s_mul_i32 s62, s60, 24
    s_lshl_b32 s70, s70, 3
    s_mov_b32 s72, 0x2aab2000
    s_mov_b32 s73, 0x80004000
    s_lshr_b64 s[64:65], s[72:73], s70
    s_and_b32 s63, s64, 0xffff
    s_sub_u32 s70, 48, s70
    s_lshr_b64 s[64:65], s[72:73], s70
    s_and_b32 s64, s64, 0xffff
    v_mov_b32 v105, s60
    v_mov_b32 v106, s63
    v_mov_b32 v107, s61
    v_mov_b32 v108, s64
    v_add_u32 v100, 0, v0
    v_cmp_gt_u32 vcc, s62, v100
    v_subrev_u32 v101, s62, v100
    v_min_u32 v100, v100, v101
    v_cndmask_b32_e64 v101, v108, v106, vcc
    v_cndmask_b32_e64 v103, v107, v105, vcc
    v_mul_u32_u24 v101, v101, v100
    v_lshrrev_b32 v101, 16, v101
    v_mul_u32_u24 v102, v101, v103
    v_sub_u32 v100, v100, v102
    v_and_b32 v102, 7, v101
    v_and_b32 v104, 2, v103
    v_sub_u32 v104, 2, v104
    v_mul_u32_u24 v104, v104, v103
    v_mul_u32_u24 v104, v104, v102
    v_lshrrev_b32 v104, 5, v104
    v_lshlrev_b32 v104, 1, v104
    v_xor_b32 v100, v100, v104
    v_cndmask_b32_e64 v104, v105, 0, vcc
    v_add_u32 v100, v100, v104
    v_lshrrev_b32 v101, 3, v101
    v_mul_u32_u24 v101, 1280, v101
    v_lshl_add_u32 v100, v100, 4, v101
    v_and_b32 v103, 4, v102
    v_add_u32 v102, v102, v103
    v_mul_u32_u24 v102, 3840, v102
    v_add_u32 v100, 4096, v100
    v_add_u32 v86, v100, v102
    v_add_u32 v100, 64, v0
    v_cmp_gt_u32 vcc, s62, v100
    v_subrev_u32 v101, s62, v100
    v_min_u32 v100, v100, v101
    v_cndmask_b32_e64 v101, v108, v106, vcc
    v_cndmask_b32_e64 v103, v107, v105, vcc
    v_mul_u32_u24 v101, v101, v100
    v_lshrrev_b32 v101, 16, v101
    v_mul_u32_u24 v102, v101, v103
    v_sub_u32 v100, v100, v102
    v_and_b32 v102, 7, v101
    v_and_b32 v104, 2, v103
    v_sub_u32 v104, 2, v104
    v_mul_u32_u24 v104, v104, v103
    v_mul_u32_u24 v104, v104, v102
    v_lshrrev_b32 v104, 5, v104
    v_lshlrev_b32 v104, 1, v104
    v_xor_b32 v100, v100, v104
    v_cndmask_b32_e64 v104, v105, 0, vcc
    v_add_u32 v100, v100, v104
    v_lshrrev_b32 v101, 3, v101
    v_mul_u32_u24 v101, 1280, v101
    v_lshl_add_u32 v100, v100, 4, v101
    v_and_b32 v103, 4, v102
    v_add_u32 v102, v102, v103
    v_mul_u32_u24 v102, 3840, v102
    v_add_u32 v100, 3072, v100
    v_add_u32 v87, v100, v102
    v_add_u32 v100, 128, v0
    v_cmp_gt_u32 vcc, s62, v100
    v_subrev_u32 v101, s62, v100
    v_min_u32 v100, v100, v101
    v_cndmask_b32_e64 v101, v108, v106, vcc
    v_cndmask_b32_e64 v103, v107, v105, vcc
    v_mul_u32_u24 v101, v101, v100
    v_lshrrev_b32 v101, 16, v101
    v_mul_u32_u24 v102, v101, v103
    v_sub_u32 v100, v100, v102
    v_and_b32 v102, 7, v101
    v_and_b32 v104, 2, v103
    v_sub_u32 v104, 2, v104
    v_mul_u32_u24 v104, v104, v103
    v_mul_u32_u24 v104, v104, v102
    v_lshrrev_b32 v104, 5, v104
    v_lshlrev_b32 v104, 1, v104
    v_xor_b32 v100, v100, v104
    v_cndmask_b32_e64 v104, v105, 0, vcc
    v_add_u32 v100, v100, v104
    v_lshrrev_b32 v101, 3, v101
    v_mul_u32_u24 v101, 1280, v101
    v_lshl_add_u32 v100, v100, 4, v101
    v_and_b32 v103, 4, v102
    v_add_u32 v102, v102, v103
    v_mul_u32_u24 v102, 3840, v102
    v_add_u32 v100, 2048, v100
    v_add_u32 v88, v100, v102
    v_add_u32 v100, 192, v0
    v_cmp_gt_u32 vcc, s62, v100
    v_subrev_u32 v101, s62, v100
    v_min_u32 v100, v100, v101
    v_cndmask_b32_e64 v101, v108, v106, vcc
    v_cndmask_b32_e64 v103, v107, v105, vcc
    v_mul_u32_u24 v101, v101, v100
    v_lshrrev_b32 v101, 16, v101
    v_mul_u32_u24 v102, v101, v103
    v_sub_u32 v100, v100, v102
    v_and_b32 v102, 7, v101
    v_and_b32 v104, 2, v103
    v_sub_u32 v104, 2, v104
    v_mul_u32_u24 v104, v104, v103
    v_mul_u32_u24 v104, v104, v102
    v_lshrrev_b32 v104, 5, v104
    v_lshlrev_b32 v104, 1, v104
    v_xor_b32 v100, v100, v104
    v_cndmask_b32_e64 v104, v105, 0, vcc
    v_add_u32 v100, v100, v104
    v_lshrrev_b32 v101, 3, v101
    v_mul_u32_u24 v101, 1280, v101
    v_lshl_add_u32 v100, v100, 4, v101
    v_and_b32 v103, 4, v102
    v_add_u32 v102, v102, v103
    v_mul_u32_u24 v102, 3840, v102
    v_add_u32 v100, 1024, v100
    v_add_u32 v89, v100, v102
    v_mov_b32 v100, 2147483648
    v_cmp_gt_u32 vcc, 48, v0
    s_nop 1
    v_cndmask_b32_e64 v89, v100, v89, vcc
    s_waitcnt lgkmcnt(0)
    s_mov_b32 s28, s4
    s_mov_b32 s29, s5
    s_mov_b32 s30, 2621440
    s_mov_b32 s31, 0x20000
    s_sub_u32 s32, s16, 4096
    s_subb_u32 s33, s17, 0
    s_mov_b32 s34, 2461696
    s_mov_b32 s35, 0x20000
    s_mov_b32 s69, 94208
    s_add_u32 m0, s69, s76
    s_nop 0
    buffer_load_dwordx4 v82, s[28:31], s66 offen offset:0 lds
    buffer_load_dwordx4 v83, s[28:31], s66 offen offset:1024 lds
    buffer_load_dwordx4 v84, s[28:31], s66 offen offset:2048 lds
    s_mov_b32 exec_hi, 0
    buffer_load_dwordx4 v85, s[28:31], s66 offen offset:3072 lds
    s_mov_b32 exec_hi, -1
    s_add_u32 m0, s69, s77
    s_nop 0
    buffer_load_dwordx4 v86, s[32:35], s67 offen offset:0 lds
    buffer_load_dwordx4 v87, s[32:35], s67 offen offset:1024 lds
    buffer_load_dwordx4 v88, s[32:35], s67 offen offset:2048 lds
    buffer_load_dwordx4 v89, s[32:35], s67 offen offset:3072 lds
    s_mov_b32 s36, s26
    s_mov_b32 s37, s27
    s_mov_b32 s38, 5505024
    s_mov_b32 s39, 0x20000
    s_mov_b32 s40, s18
    s_mov_b32 s41, s19
    s_mov_b32 s42, 819200
    s_mov_b32 s43, 0x20000
    s_mov_b32 s44, s24
    s_mov_b32 s45, s25
    s_mov_b32 s46, 256
    s_mov_b32 s47, 0x20000
    v_mov_b32 v100, 163832
    v_mov_b32 v101, 0
    ds_write_b32 v100, v101
    s_setprio 1
    s_mul_i32 s70, s52, 40
    s_sub_u32 s71, 320, s70
    s_cmp_lt_u32 s52, 4
    s_cselect_b32 s70, s70, s71
    s_cselect_b32 s71, 16, -16
    s_cselect_b32 s73, 0, -16
    s_mul_i32 s72, s54, 5376
    s_add_u32 s70, s70, s72
    s_lshl_b32 s70, s70, 4
    s_add_u32 s70, s70, 2621440
    v_add_u32 v100, 0, v0
    v_mul_u32_u24 v101, 1639, v100
    v_lshrrev_b32 v101, 16, v101
    v_mul_u32_u24 v102, 40, v101
    v_sub_u32 v100, v100, v102
    v_mul_i32_i24 v100, s71, v100
    v_and_b32 v102, 1, v101
    v_mul_i32_i24 v102, s73, v102
    v_mul_u32_u24 v101, 2688, v101
    v_add3_u32 v100, v100, v101, v102
    v_add_u32 v77, s70, v100
    v_add_u32 v100, 64, v0
    v_mul_u32_u24 v101, 1639, v100
    v_lshrrev_b32 v101, 16, v101
    v_mul_u32_u24 v102, 40, v101
    v_sub_u32 v100, v100, v102
    v_mul_i32_i24 v100, s71, v100
    v_and_b32 v102, 1, v101
    v_mul_i32_i24 v102, s73, v102
    v_mul_u32_u24 v101, 2688, v101
    v_add3_u32 v100, v100, v101, v102
    v_add_u32 v78, s70, v100
    v_subrev_u32 v78, 1024, v78
    v_add_u32 v100, 128, v0
    v_mul_u32_u24 v101, 1639, v100
    v_lshrrev_b32 v101, 16, v101
    v_mul_u32_u24 v102, 40, v101
    v_sub_u32 v100, v100, v102
    v_mul_i32_i24 v100, s71, v100
    v_and_b32 v102, 1, v101
    v_mul_i32_i24 v102, s73, v102
    v_mul_u32_u24 v101, 2688, v101
    v_add3_u32 v100, v100, v101, v102
    v_add_u32 v79, s70, v100
    v_subrev_u32 v79, 2048, v79
    v_add_u32 v100, 192, v0
    v_mul_u32_u24 v101, 1639, v100
    v_lshrrev_b32 v101, 16, v101
    v_mul_u32_u24 v102, 40, v101
    v_sub_u32 v100, v100, v102
    v_mul_i32_i24 v100, s71, v100
    v_and_b32 v102, 1, v101
    v_mul_i32_i24 v102, s73, v102
    v_mul_u32_u24 v101, 2688, v101
    v_add3_u32 v100, v100, v101, v102
    v_add_u32 v80, s70, v100
    v_subrev_u32 v80, 3072, v80
    v_add_u32 v100, 256, v0
    v_mul_u32_u24 v101, 1639, v100
    v_lshrrev_b32 v101, 16, v101
    v_mul_u32_u24 v102, 40, v101
    v_sub_u32 v100, v100, v102
    v_mul_i32_i24 v100, s71, v100
    v_and_b32 v102, 1, v101
    v_mul_i32_i24 v102, s73, v102
    v_mul_u32_u24 v101, 2688, v101
    v_add3_u32 v100, v100, v101, v102
    v_add_u32 v81, s70, v100
    s_lshr_b32 s56, s3, 2
    v_and_b32 v2, 15, v0
    v_lshrrev_b32 v3, 4, v0
    v_bfe_u32 v4, v0, 2, 3
    v_lshrrev_b32 v5, 5, v0
    v_lshl_add_u32 v4, v5, 4, v4
    v_mul_u32_u24 v4, 160, v4
    v_and_b32 v5, 3, v0
    v_lshl_add_u32 v4, v5, 3, v4
    s_mul_i32 s58, s56, 35840
    v_add_u32 v8, s58, v4
    s_mul_i32 s58, s56, 15360
    s_add_u32 s58, s58, 71680
    v_add_u32 v9, s58, v4
    s_and_b32 s65, s2, 7
    s_lshl_b32 s65, s65, 13
    s_add_u32 s65, s65, 5439488
    s_and_b32 s70, s50, 3
    s_mul_i32 s70, s70, 640
    s_add_u32 s60, s65, s70
    s_and_b32 s70, s50, 4
    s_lshl_b32 s70, s70, 10
    s_add_u32 s60, s60, s70
    v_lshlrev_b32 v21, 7, v0
    v_and_b32 v4, 1, v2
    v_mul_u32_u24 v4, 640, v4
    v_lshrrev_b32 v5, 1, v2
    v_lshl_add_u32 v4, v5, 4, v4
    v_mul_u32_u24 v5, 5120, v3
    s_mov_b32 s57, 112640
    v_add3_u32 v23, v4, v5, s57
    s_lshl_b32 s57, s51, 6
    s_add_u32 s57, s57, 133120
    v_lshlrev_b32 v7, 2, v2
    v_add_u32 v7, s57, v7
    s_mul_i32 s71, s50, 52
    s_lshr_b32 s71, s71, 8
    s_mul_i32 s70, s71, 5
    s_sub_u32 s70, s50, s70
    s_lshl_b32 s71, s71, 2
    s_add_u32 s71, s71, s49
    s_lshl_b32 s71, 1, s71
    s_and_b32 s71, s71, 65535
    v_mov_b32 v4, s71
    v_cmp_eq_u32 vcc, s70, v0
    s_nop 1
    v_cndmask_b32_e64 v192, 0, v4, vcc
    v_mov_b32 v196, v77
    v_mov_b32 v197, v78
    v_mov_b32 v198, v79
    v_mov_b32 v199, v80
    v_mov_b32 v200, v81
    s_mul_i32 s57, s53, 1280
    s_mul_i32 s58, s52, 160
    s_add_u32 s57, s57, s58
    s_lshl_b32 s58, s3, 6
    s_add_u32 s58, s58, 0
    s_mov_b32 s59, 133120
    v_add_u32 v4, s58, v0
    v_mul_u32_u24 v5, 6554, v4
    v_lshrrev_b32 v5, 16, v5
    v_lshl_add_u32 v249, v5, 2, s59
    v_mul_u32_u24 v6, 10, v5
    v_sub_u32 v4, v4, v6
    v_mul_u32_u24 v6, 40960, v5
    v_lshl_add_u32 v6, v4, 4, v6
    v_add_u32 v26, s57, v6
    v_mul_u32_u24 v6, 336, v5
    v_lshl_add_u32 v4, v4, 5, v6
    v_lshrrev_b32 v5, 4, v5
    v_mul_u32_u24 v6, 4864, v5
    v_add_u32 v252, v4, v6
    v_add_u32 v5, 1, v5
    v_lshrrev_b32 v5, 2, v5
    v_mul_u32_u24 v5, 30720, v5
    v_add_u32 v253, v252, v5
    s_lshl_b32 s57, s56, 1
    s_add_u32 s57, s57, s52
    s_add_u32 s57, s57, 0
    s_and_b32 s57, s57, 3
    s_lshl_b32 s58, s53, 2
    s_add_u32 s57, s57, s58
    s_lshl_b32 s57, s57, 3
    s_add_u32 s57, s57, s51
    s_mul_i32 s62, s57, 2560
    s_lshl_b32 s57, s56, 1
    s_add_u32 s57, s57, s52
    s_add_u32 s57, s57, 1
    s_and_b32 s57, s57, 3
    s_lshl_b32 s58, s53, 2
    s_add_u32 s57, s57, s58
    s_lshl_b32 s57, s57, 3
    s_add_u32 s57, s57, s51
    s_mul_i32 s63, s57, 2560
    s_mul_i32 s61, s3, 10240
    s_cmp_eq_u32 s3, 7
    s_cselect_b32 s61, 102400, s61
    v_and_b32 v4, 1, v3
    v_lshrrev_b32 v5, 1, v3
    v_xor_b32 v5, v5, v4
    v_mul_u32_u24 v4, 2560, v4
    v_lshl_add_u32 v4, v5, 4, v4
    v_mul_u32_u24 v5, 160, v2
    v_add3_u32 v20, v4, v5, s61
    v_mul_u32_u24 v22, 336, v2
    v_lshl_add_u32 v22, v3, 4, v22
    v_add_u32 v22, s61, v22
    s_setprio 0
    s_add_u32 m0, s69, s77
    s_add_u32 m0, m0, 16384
    s_nop 0
    buffer_load_dwordx4 v86, s[32:35], s68 offen offset:0 lds
    buffer_load_dwordx4 v87, s[32:35], s68 offen offset:1024 lds
    buffer_load_dwordx4 v88, s[32:35], s68 offen offset:2048 lds
    buffer_load_dwordx4 v89, s[32:35], s68 offen offset:3072 lds
    s_add_u32 s70, s81, 5
    s_sub_u32 s71, s81, 4
    s_cmp_eq_u32 s81, 9
    s_cselect_b32 s71, 0, s71
    s_cmp_lt_u32 s81, 5
    s_cselect_b32 s81, s70, s71
    s_lshl_b32 s66, s81, 7
    s_add_u32 s66, s66, s78
    s_mul_i32 s67, s81, 245760
    s_add_u32 s67, s67, s79
    s_add_u32 s68, s67, 122880
    s_add_u32 s69, s69, 47104
    s_cmp_eq_u32 s69, 141312
    s_cselect_b32 s69, 0, s69
    s_waitcnt vmcnt(4)
    s_barrier
    s_add_u32 m0, s69, s76
    s_nop 0
    buffer_load_dwordx4 v82, s[28:31], s66 offen offset:0 lds
    buffer_load_dwordx4 v83, s[28:31], s66 offen offset:1024 lds
    buffer_load_dwordx4 v84, s[28:31], s66 offen offset:2048 lds
    s_mov_b32 exec_hi, 0
    buffer_load_dwordx4 v85, s[28:31], s66 offen offset:3072 lds
    s_mov_b32 exec_hi, -1
    s_add_u32 m0, s69, s77
    s_nop 0
    buffer_load_dwordx4 v86, s[32:35], s67 offen offset:0 lds
    buffer_load_dwordx4 v87, s[32:35], s67 offen offset:1024 lds
    s_waitcnt vmcnt(6)
    s_barrier
    s_add_u32 m0, s69, s77
    s_nop 0
    buffer_load_dwordx4 v88, s[32:35], s67 offen offset:2048 lds
    buffer_load_dwordx4 v89, s[32:35], s67 offen offset:3072 lds
    s_add_u32 m0, s69, s77
    s_add_u32 m0, m0, 16384
    s_nop 0
    buffer_load_dwordx4 v86, s[32:35], s68 offen offset:0 lds
    buffer_load_dwordx4 v87, s[32:35], s68 offen offset:1024 lds
    buffer_load_dwordx4 v88, s[32:35], s68 offen offset:2048 lds
    buffer_load_dwordx4 v89, s[32:35], s68 offen offset:3072 lds
    s_add_u32 s70, s81, 5
    s_sub_u32 s71, s81, 4
    s_cmp_eq_u32 s81, 9
    s_cselect_b32 s71, 0, s71
    s_cmp_lt_u32 s81, 5
    s_cselect_b32 s81, s70, s71
    s_lshl_b32 s66, s81, 7
    s_add_u32 s66, s66, s78
    s_mul_i32 s67, s81, 245760
    s_add_u32 s67, s67, s79
    s_add_u32 s68, s67, 122880
    s_add_u32 s69, s69, 47104
    s_cmp_eq_u32 s69, 141312
    s_cselect_b32 s69, 0, s69
    s_mov_b32 s75, 1
QL_LOOP:
    s_add_u32 m0, s69, s76
    s_nop 0
    buffer_load_dwordx4 v82, s[28:31], s66 offen offset:0 lds
    buffer_load_dwordx4 v83, s[28:31], s66 offen offset:1024 lds
    buffer_load_dwordx4 v84, s[28:31], s66 offen offset:2048 lds
    s_mov_b32 exec_hi, 0
    buffer_load_dwordx4 v85, s[28:31], s66 offen offset:3072 lds
    s_mov_b32 exec_hi, -1
    s_add_u32 m0, s69, s77
    s_nop 0
    buffer_load_dwordx4 v86, s[32:35], s67 offen offset:0 lds
    buffer_load_dwordx4 v87, s[32:35], s67 offen offset:1024 lds
    buffer_load_dwordx4 v88, s[32:35], s67 offen offset:2048 lds
    buffer_load_dwordx4 v89, s[32:35], s67 offen offset:3072 lds
    s_add_u32 m0, s69, s77
    s_add_u32 m0, m0, 16384
    s_nop 0
    buffer_load_dwordx4 v86, s[32:35], s68 offen offset:0 lds
    buffer_load_dwordx4 v87, s[32:35], s68 offen offset:1024 lds
    s_waitcnt vmcnt(10)
    s_barrier
    s_add_u32 m0, s69, s77
    s_add_u32 m0, m0, 16384
    s_nop 0
    buffer_load_dwordx4 v88, s[32:35], s68 offen offset:2048 lds
    buffer_load_dwordx4 v89, s[32:35], s68 offen offset:3072 lds
    s_add_u32 s70, s81, 5
    s_sub_u32 s71, s81, 4
    s_cmp_eq_u32 s81, 9
    s_cselect_b32 s71, 0, s71
    s_cmp_lt_u32 s81, 5
    s_cselect_b32 s81, s70, s71
    s_lshl_b32 s66, s81, 7
    s_add_u32 s66, s66, s78
    s_mul_i32 s67, s81, 245760
    s_add_u32 s67, s67, s79
    s_add_u32 s68, s67, 122880
    s_add_u32 s69, s69, 47104
    s_cmp_eq_u32 s69, 141312
    s_cselect_b32 s69, 0, s69
    s_add_u32 s75, s75, 1
    s_cmp_lt_u32 s75, 9
    s_cbranch_scc1 QL_LOOP
    s_load_dwordx8 s[76:83], s[24:25], 0
    v_lshlrev_b32 v10, 4, v0
    v_mov_b32 v11, v10
    v_xor_b32 v4, 16, v10
    v_add_u32 v13, 7680, v4
    v_add_u32 v14, 11776, v4
    v_add_u32 v12, 7680, v4
    s_mov_b32 exec_hi, 0
    v_mov_b32 v12, v10
    s_mov_b32 exec_hi, -1
    v_add_u32 v100, 0, v0
    v_mul_u32_u24 v101, 6554, v100
    v_lshrrev_b32 v101, 16, v101
    v_mul_u32_u24 v102, 10, v101
    v_sub_u32 v100, v100, v102
    v_and_b32 v102, 3, v101
    v_and_b32 v72, 4, v101
    v_mul_u32_u24 v72, 20, v72
    v_and_b32 v101, 24, v101
    v_lshrrev_b32 v101, 1, v101
    v_add3_u32 v102, v102, v101, v72
    v_mul_u32_u24 v102, 1280, v102
    v_lshl_add_u32 v72, v100, 4, v102
    v_add_u32 v100, 64, v0
    v_mul_u32_u24 v101, 6554, v100
    v_lshrrev_b32 v101, 16, v101
    v_mul_u32_u24 v102, 10, v101
    v_sub_u32 v100, v100, v102
    v_and_b32 v102, 3, v101
    v_and_b32 v73, 4, v101
    v_mul_u32_u24 v73, 20, v73
    v_and_b32 v101, 24, v101
    v_lshrrev_b32 v101, 1, v101
    v_add3_u32 v102, v102, v101, v73
    v_mul_u32_u24 v102, 1280, v102
    v_lshl_add_u32 v73, v100, 4, v102
    v_subrev_u32 v73, 1024, v73
    v_add_u32 v100, 128, v0
    v_mul_u32_u24 v101, 6554, v100
    v_lshrrev_b32 v101, 16, v101
    v_mul_u32_u24 v102, 10, v101
    v_sub_u32 v100, v100, v102
    v_and_b32 v102, 3, v101
    v_and_b32 v74, 4, v101
    v_mul_u32_u24 v74, 20, v74
    v_and_b32 v101, 24, v101
    v_lshrrev_b32 v101, 1, v101
    v_add3_u32 v102, v102, v101, v74
    v_mul_u32_u24 v102, 1280, v102
    v_lshl_add_u32 v74, v100, 4, v102
    v_subrev_u32 v74, 2048, v74
    v_add_u32 v100, 192, v0
    v_mul_u32_u24 v101, 6554, v100
    v_lshrrev_b32 v101, 16, v101
    v_mul_u32_u24 v102, 10, v101
    v_sub_u32 v100, v100, v102
    v_and_b32 v102, 3, v101
    v_and_b32 v75, 4, v101
    v_mul_u32_u24 v75, 20, v75
    v_and_b32 v101, 24, v101
    v_lshrrev_b32 v101, 1, v101
    v_add3_u32 v102, v102, v101, v75
    v_mul_u32_u24 v102, 1280, v102
    v_lshl_add_u32 v75, v100, 4, v102
    v_subrev_u32 v75, 3072, v75
    v_add_u32 v100, 256, v0
    v_mul_u32_u24 v101, 6554, v100
    v_lshrrev_b32 v101, 16, v101
    v_mul_u32_u24 v102, 10, v101
    v_sub_u32 v100, v100, v102
    v_and_b32 v102, 3, v101
    v_and_b32 v76, 4, v101
    v_mul_u32_u24 v76, 20, v76
    v_and_b32 v101, 24, v101
    v_lshrrev_b32 v101, 1, v101
    v_add3_u32 v102, v102, v101, v76
    v_mul_u32_u24 v102, 1280, v102
    v_lshl_add_u32 v76, v100, 4, v102
    v_mov_b32 v251, v249
    v_mov_b32 v27, 2147483648
    s_waitcnt vmcnt(4)
    s_barrier
    s_lshl_b32 s70, s51, 3
    s_lshr_b32 s70, 0x3020100, s70
    s_and_b32 s71, s70, 15
    s_mul_i32 s71, s71, 20480
    s_lshr_b32 s70, s70, 4
    s_add_u32 s70, s70, s52
    s_and_b32 s70, s70, 3
    s_mul_i32 s70, s70, 204800
    s_add_u32 s71, s71, s70
    s_mul_i32 s70, s52, 160
    s_add_u32 s71, s71, s70
    s_mul_i32 s70, s51, 5120
    s_add_u32 m0, s70, 0
    s_nop 0
    buffer_load_dwordx4 v72, s[40:43], s71 offen offset:0 lds
    buffer_load_dwordx4 v73, s[40:43], s71 offen offset:1024 lds
    buffer_load_dwordx4 v74, s[40:43], s71 offen offset:2048 lds
    buffer_load_dwordx4 v75, s[40:43], s71 offen offset:3072 lds
    s_add_u32 m0, m0, 4096
    s_nop 0
    buffer_load_dwordx4 v76, s[40:43], s71 offen offset:0 lds
    s_waitcnt vmcnt(5)
    s_barrier
    s_lshl_b32 s70, s51, 3
    s_lshr_b32 s70, 0x20111004, s70
    s_and_b32 s71, s70, 15
    s_mul_i32 s71, s71, 20480
    s_lshr_b32 s70, s70, 4
    s_add_u32 s70, s70, s52
    s_and_b32 s70, s70, 3
    s_mul_i32 s70, s70, 204800
    s_add_u32 s71, s71, s70
    s_mul_i32 s70, s52, 160
    s_add_u32 s71, s71, s70
    s_mul_i32 s70, s51, 5120
    s_add_u32 m0, s70, 20480
    s_nop 0
    buffer_load_dwordx4 v72, s[40:43], s71 offen offset:0 lds
    buffer_load_dwordx4 v73, s[40:43], s71 offen offset:1024 lds
    buffer_load_dwordx4 v74, s[40:43], s71 offen offset:2048 lds
    buffer_load_dwordx4 v75, s[40:43], s71 offen offset:3072 lds
    s_add_u32 m0, m0, 4096
    s_nop 0
    buffer_load_dwordx4 v76, s[40:43], s71 offen offset:0 lds
    s_waitcnt lgkmcnt(0)
    s_barrier
    s_lshl_b32 s70, s51, 3
    s_lshr_b32 s70, 0x24232221, s70
    s_and_b32 s71, s70, 15
    s_mul_i32 s71, s71, 20480
    s_lshr_b32 s70, s70, 4
    s_add_u32 s70, s70, s52
    s_and_b32 s70, s70, 3
    s_mul_i32 s70, s70, 204800
    s_add_u32 s71, s71, s70
    s_mul_i32 s70, s52, 160
    s_add_u32 s71, s71, s70
    s_mul_i32 s70, s51, 5120
    s_add_u32 m0, s70, 40960
    s_nop 0
    buffer_load_dwordx4 v72, s[40:43], s71 offen offset:0 lds
    buffer_load_dwordx4 v73, s[40:43], s71 offen offset:1024 lds
    buffer_load_dwordx4 v74, s[40:43], s71 offen offset:2048 lds
    buffer_load_dwordx4 v75, s[40:43], s71 offen offset:3072 lds
    s_add_u32 m0, m0, 4096
    s_nop 0
    buffer_load_dwordx4 v76, s[40:43], s71 offen offset:0 lds
    s_lshl_b32 s70, s51, 3
    s_lshr_b32 s70, 0x13123130, s70
    s_and_b32 s71, s70, 15
    s_mul_i32 s71, s71, 20480
    s_lshr_b32 s70, s70, 4
    s_add_u32 s70, s70, s52
    s_and_b32 s70, s70, 3
    s_mul_i32 s70, s70, 204800
    s_add_u32 s71, s71, s70
    s_mul_i32 s70, s52, 160
    s_add_u32 s71, s71, s70
    s_mul_i32 s70, s51, 5120
    s_add_u32 m0, s70, 61440
    s_nop 0
    buffer_load_dwordx4 v72, s[40:43], s71 offen offset:0 lds
    buffer_load_dwordx4 v73, s[40:43], s71 offen offset:1024 lds
    buffer_load_dwordx4 v74, s[40:43], s71 offen offset:2048 lds
    buffer_load_dwordx4 v75, s[40:43], s71 offen offset:3072 lds
    s_add_u32 m0, m0, 4096
    s_nop 0
    buffer_load_dwordx4 v76, s[40:43], s71 offen offset:0 lds
    s_lshl_b32 s70, s51, 3
    s_lshr_b32 s70, 0x34333214, s70
    s_and_b32 s71, s70, 15
    s_mul_i32 s71, s71, 20480
    s_lshr_b32 s70, s70, 4
    s_add_u32 s70, s70, s52
    s_and_b32 s70, s70, 3
    s_mul_i32 s70, s70, 204800
    s_add_u32 s71, s71, s70
    s_mul_i32 s70, s52, 160
    s_add_u32 s71, s71, s70
    s_mul_i32 s70, s51, 5120
    s_add_u32 m0, s70, 81920
    s_nop 0
    buffer_load_dwordx4 v72, s[40:43], s71 offen offset:0 lds
    buffer_load_dwordx4 v73, s[40:43], s71 offen offset:1024 lds
    buffer_load_dwordx4 v74, s[40:43], s71 offen offset:2048 lds
    buffer_load_dwordx4 v75, s[40:43], s71 offen offset:3072 lds
    s_add_u32 m0, m0, 4096
    s_nop 0
    buffer_load_dwordx4 v76, s[40:43], s71 offen offset:0 lds
    s_waitcnt lgkmcnt(0)
    s_and_b64 s[76:77], s[76:77], s[78:79]
    s_and_b64 s[80:81], s[80:81], s[82:83]
    s_and_b64 s[76:77], s[76:77], s[80:81]
    s_and_b32 s76, s76, s77
    s_cbranch_scc1 L_COK1
    s_mov_b32 s71, 0
    v_lshlrev_b32 v100, 2, v0
    s_mov_b64 exec, 0xff
L_CLP2:
    s_sleep 16
    buffer_load_dword v101, v100, s[44:47], 0 offen sc1
    s_waitcnt vmcnt(0)
    v_cmp_eq_u32 vcc, 0, v101
    s_cbranch_vccz L_CLP2x
    s_add_u32 s71, s71, 1
    s_cmp_gt_u32 s71, 200000
    s_cbranch_scc0 L_CLP2
L_CLP2x:
    s_mov_b64 exec, -1
L_COK1:
    s_branch L_P2H2
L_AUX:
    s_sub_u32 s56, s50, 20
    s_lshl_b32 s56, s56, 3
    s_add_u32 s56, s56, s3
    v_and_b32 v13, 31, v0
    v_mul_u32_u24 v13, 2560, v13
    v_lshrrev_b32 v2, 5, v0
    v_mul_u32_u24 v2, 640, v2
    v_add_u32 v13, v13, v2
    s_lshl_b32 s59, s56, 6
    s_add_u32 s59, s59, s48
    s_mul_i32 s59, s59, 1280
    v_lshlrev_b32 v8, 7, v0
    s_waitcnt lgkmcnt(0)
    s_mov_b32 s28, s4
    s_mov_b32 s29, s5
    s_mov_b32 s30, 2621440
    s_mov_b32 s31, 0x20000
    s_add_u32 s70, s55, 1
    s_sub_u32 s71, s70, 5
    s_min_u32 s70, s70, s71
    s_lshl_b32 s70, s70, 7
    s_add_u32 s70, s70, s59
    buffer_load_dword v12, v13, s[28:31], s70 offen
    s_barrier
    s_mov_b32 s32, s20
    s_mov_b32 s33, s21
    s_mov_b32 s34, 1280
    s_mov_b32 s35, 0x20000
    s_and_b32 s70, s3, 1
    s_lshl_b32 s70, s70, 10
    s_add_u32 m0, s70, 102400
    v_lshlrev_b32 v2, 4, v0
    buffer_load_dwordx4 v2, s[32:35], s70 offen lds
    s_lshl_b32 s57, s56, 6
    s_add_u32 s57, s57, 1760
    s_mul_i32 s58, s49, 320
    s_and_b32 s58, s58, 0xffffff80
    s_mov_b32 s32, s16
    s_mov_b32 s33, s17
    s_mov_b32 s34, 2457600
    s_mov_b32 s35, 0x20000
    s_mov_b32 s36, s26
    s_mov_b32 s37, s27
    s_mov_b32 s38, 5505024
    s_mov_b32 s39, 0x20000
    s_mov_b32 s44, s24
    s_mov_b32 s45, s25
    s_mov_b32 s46, 256
    s_mov_b32 s47, 0x20000
    s_mov_b32 s40, s18
    s_mov_b32 s41, s19
    s_mov_b32 s42, 819200
    s_mov_b32 s43, 0x20000
    v_add_u32 v2, s57, v0
    v_cmp_gt_u32 vcc, 5760, v2
    v_mul_u32_u24 v3, 7282, v2
    v_lshrrev_b32 v3, 16, v3
    v_mul_u32_u24 v4, 9, v3
    v_sub_u32 v2, v2, v4
    v_mul_u32_u24 v4, 11, v2
    v_lshrrev_b32 v4, 5, v4
    v_mul_u32_u24 v4, 896, v4
    v_lshl_add_u32 v2, v2, 7, v4
    v_and_b32 v4, 63, v3
    v_lshrrev_b32 v6, 7, v3
    v_add_u32 v6, s55, v6
    v_subrev_u32 v5, 5, v6
    v_min_u32 v6, v6, v5
    v_lshl_add_u32 v4, v6, 6, v4
    v_and_b32 v3, 64, v3
    v_mul_u32_u24 v3, 5, v3
    v_add_u32 v3, v3, v4
    v_mul_u32_u24 v3, 3840, v3
    v_add_u32 v2, v2, v3
    v_mov_b32 v3, 2147483648
    v_cndmask_b32_e64 v6, v3, v2, vcc
    buffer_load_dword v12, v6, s[32:35], s58 offen
    s_barrier
    s_add_u32 s57, s57, 2048
    v_add_u32 v2, s57, v0
    v_cmp_gt_u32 vcc, 5760, v2
    v_mul_u32_u24 v3, 7282, v2
    v_lshrrev_b32 v3, 16, v3
    v_mul_u32_u24 v4, 9, v3
    v_sub_u32 v2, v2, v4
    v_mul_u32_u24 v4, 11, v2
    v_lshrrev_b32 v4, 5, v4
    v_mul_u32_u24 v4, 896, v4
    v_lshl_add_u32 v2, v2, 7, v4
    v_and_b32 v4, 63, v3
    v_lshrrev_b32 v6, 7, v3
    v_add_u32 v6, s55, v6
    v_subrev_u32 v5, 5, v6
    v_min_u32 v6, v6, v5
    v_lshl_add_u32 v4, v6, 6, v4
    v_and_b32 v3, 64, v3
    v_mul_u32_u24 v3, 5, v3
    v_add_u32 v3, v3, v4
    v_mul_u32_u24 v3, 3840, v3
    v_add_u32 v2, v2, v3
    v_mov_b32 v3, 2147483648
    v_cndmask_b32_e64 v6, v3, v2, vcc
    buffer_load_dword v12, v6, s[32:35], s58 offen
    s_barrier
    s_add_u32 s57, s57, 2048
    s_lshl_b32 s60, s49, 2
    s_add_u32 s60, s60, s50
    s_sub_u32 s60, s60, 20
    s_lshl_b32 s60, s60, 1
    s_add_u32 s60, s60, s48
    s_lshl_b32 s70, s3, 8
    s_add_u32 s70, s70, s60
    v_lshrrev_b32 v2, 3, v0
    v_lshlrev_b32 v9, 2, v2
    v_lshlrev_b32 v2, 5, v2
    v_add_u32 v2, s70, v2
    v_and_b32 v3, 7, v0
    v_lshlrev_b32 v3, 4, v3
    v_mul_u32_u24 v4, 1280, v2
    v_add_u32 v4, v4, v3
    s_lshl_b32 s70, s3, 5
    s_add_u32 s70, s70, 104448
    v_add_u32 v9, s70, v9
    v_add_u32 v10, 102400, v3
    buffer_load_dwordx4 v[108:111], v4, s[28:31], 0 offen offset:256
    buffer_load_dwordx4 v[128:131], v4, s[28:31], 0 offen offset:896
    buffer_load_dwordx4 v[112:115], v4, s[28:31], 0 offen offset:384
    buffer_load_dwordx4 v[132:135], v4, s[28:31], 0 offen offset:1024
    buffer_load_dwordx4 v[116:119], v4, s[28:31], 0 offen offset:512
    buffer_load_dwordx4 v[136:139], v4, s[28:31], 0 offen offset:1152
    buffer_load_dwordx4 v[100:103], v4, s[28:31], 0 offen offset:0
    buffer_load_dwordx4 v[120:123], v4, s[28:31], 0 offen offset:640
    buffer_load_dwordx4 v[104:107], v4, s[28:31], 0 offen offset:128
    buffer_load_dwordx4 v[124:127], v4, s[28:31], 0 offen offset:768
    s_barrier
    s_and_b32 s57, s2, 7
    s_lshl_b32 s57, s57, 5
    s_add_u32 s57, s57, s56
    s_mul_i32 s70, s56, 25600
    s_add_u32 s70, s70, 25600
    s_mov_b32 exec_hi, 0x3ffff
    s_mov_b32 exec_hi, -1
    v_add_u32 v2, 0, v0
    v_mul_u32_u24 v3, 6554, v2
    v_lshrrev_b32 v3, 16, v3
    v_mul_u32_u24 v4, 10, v3
    v_sub_u32 v2, v2, v4
    v_and_b32 v4, 3, v3
    v_and_b32 v72, 4, v3
    v_mul_u32_u24 v72, 20, v72
    v_and_b32 v3, 24, v3
    v_lshrrev_b32 v3, 1, v3
    v_add3_u32 v4, v4, v3, v72
    v_mul_u32_u24 v4, 1280, v4
    v_lshl_add_u32 v72, v2, 4, v4
    v_add_u32 v2, 64, v0
    v_mul_u32_u24 v3, 6554, v2
    v_lshrrev_b32 v3, 16, v3
    v_mul_u32_u24 v4, 10, v3
    v_sub_u32 v2, v2, v4
    v_and_b32 v4, 3, v3
    v_and_b32 v73, 4, v3
    v_mul_u32_u24 v73, 20, v73
    v_and_b32 v3, 24, v3
    v_lshrrev_b32 v3, 1, v3
    v_add3_u32 v4, v4, v3, v73
    v_mul_u32_u24 v4, 1280, v4
    v_lshl_add_u32 v73, v2, 4, v4
    v_subrev_u32 v73, 1024, v73
    v_add_u32 v2, 128, v0
    v_mul_u32_u24 v3, 6554, v2
    v_lshrrev_b32 v3, 16, v3
    v_mul_u32_u24 v4, 10, v3
    v_sub_u32 v2, v2, v4
    v_and_b32 v4, 3, v3
    v_and_b32 v74, 4, v3
    v_mul_u32_u24 v74, 20, v74
    v_and_b32 v3, 24, v3
    v_lshrrev_b32 v3, 1, v3
    v_add3_u32 v4, v4, v3, v74
    v_mul_u32_u24 v4, 1280, v4
    v_lshl_add_u32 v74, v2, 4, v4
    v_subrev_u32 v74, 2048, v74
    v_add_u32 v2, 192, v0
    v_mul_u32_u24 v3, 6554, v2
    v_lshrrev_b32 v3, 16, v3
    v_mul_u32_u24 v4, 10, v3
    v_sub_u32 v2, v2, v4
    v_and_b32 v4, 3, v3
    v_and_b32 v75, 4, v3
    v_mul_u32_u24 v75, 20, v75
    v_and_b32 v3, 24, v3
    v_lshrrev_b32 v3, 1, v3
    v_add3_u32 v4, v4, v3, v75
    v_mul_u32_u24 v4, 1280, v4
    v_lshl_add_u32 v75, v2, 4, v4
    v_subrev_u32 v75, 3072, v75
    v_add_u32 v2, 256, v0
    v_mul_u32_u24 v3, 6554, v2
    v_lshrrev_b32 v3, 16, v3
    v_mul_u32_u24 v4, 10, v3
    v_sub_u32 v2, v2, v4
    v_and_b32 v4, 3, v3
    v_and_b32 v76, 4, v3
    v_mul_u32_u24 v76, 20, v76
    v_and_b32 v3, 24, v3
    v_lshrrev_b32 v3, 1, v3
    v_add3_u32 v4, v4, v3, v76
    v_mul_u32_u24 v4, 1280, v4
    v_lshl_add_u32 v76, v2, 4, v4
    s_mul_i32 s70, s52, 40
    s_sub_u32 s71, 320, s70
    s_cmp_lt_u32 s52, 4
    s_cselect_b32 s70, s70, s71
    s_cselect_b32 s71, 16, -16
    s_cselect_b32 s73, 0, -16
    s_mul_i32 s72, s54, 5376
    s_add_u32 s70, s70, s72
    s_lshl_b32 s70, s70, 4
    s_add_u32 s70, s70, 2621440
    v_add_u32 v2, 0, v0
    v_mul_u32_u24 v3, 1639, v2
    v_lshrrev_b32 v3, 16, v3
    v_mul_u32_u24 v4, 40, v3
    v_sub_u32 v2, v2, v4
    v_mul_i32_i24 v2, s71, v2
    v_and_b32 v4, 1, v3
    v_mul_i32_i24 v4, s73, v4
    v_mul_u32_u24 v3, 2688, v3
    v_add3_u32 v2, v2, v3, v4
    v_add_u32 v77, s70, v2
    v_add_u32 v2, 64, v0
    v_mul_u32_u24 v3, 1639, v2
    v_lshrrev_b32 v3, 16, v3
    v_mul_u32_u24 v4, 40, v3
    v_sub_u32 v2, v2, v4
    v_mul_i32_i24 v2, s71, v2
    v_and_b32 v4, 1, v3
    v_mul_i32_i24 v4, s73, v4
    v_mul_u32_u24 v3, 2688, v3
    v_add3_u32 v2, v2, v3, v4
    v_add_u32 v78, s70, v2
    v_subrev_u32 v78, 1024, v78
    v_add_u32 v2, 128, v0
    v_mul_u32_u24 v3, 1639, v2
    v_lshrrev_b32 v3, 16, v3
    v_mul_u32_u24 v4, 40, v3
    v_sub_u32 v2, v2, v4
    v_mul_i32_i24 v2, s71, v2
    v_and_b32 v4, 1, v3
    v_mul_i32_i24 v4, s73, v4
    v_mul_u32_u24 v3, 2688, v3
    v_add3_u32 v2, v2, v3, v4
    v_add_u32 v79, s70, v2
    v_subrev_u32 v79, 2048, v79
    v_add_u32 v2, 192, v0
    v_mul_u32_u24 v3, 1639, v2
    v_lshrrev_b32 v3, 16, v3
    v_mul_u32_u24 v4, 40, v3
    v_sub_u32 v2, v2, v4
    v_mul_i32_i24 v2, s71, v2
    v_and_b32 v4, 1, v3
    v_mul_i32_i24 v4, s73, v4
    v_mul_u32_u24 v3, 2688, v3
    v_add3_u32 v2, v2, v3, v4
    v_add_u32 v80, s70, v2
    v_subrev_u32 v80, 3072, v80
    v_add_u32 v2, 256, v0
    v_mul_u32_u24 v3, 1639, v2
    v_lshrrev_b32 v3, 16, v3
    v_mul_u32_u24 v4, 40, v3
    v_sub_u32 v2, v2, v4
    v_mul_i32_i24 v2, s71, v2
    v_and_b32 v4, 1, v3
    v_mul_i32_i24 v4, s73, v4
    v_mul_u32_u24 v3, 2688, v3
    v_add3_u32 v2, v2, v3, v4
    v_add_u32 v81, s70, v2
    v_mov_b32 v7, 0
    s_waitcnt vmcnt(0)
    s_barrier
    ds_read_b128 v[140:143], v10 offset:0
    ds_read_b128 v[144:147], v10 offset:128
    ds_read_b128 v[148:151], v10 offset:256
    ds_read_b128 v[152:155], v10 offset:384
    ds_read_b128 v[156:159], v10 offset:512
    ds_read_b128 v[160:163], v10 offset:640
    ds_read_b128 v[164:167], v10 offset:768
    ds_read_b128 v[168:171], v10 offset:896
    ds_read_b128 v[172:175], v10 offset:1024
    ds_read_b128 v[176:179], v10 offset:1152
    s_waitcnt lgkmcnt(0)
    s_load_dwordx8 s[76:83], s[24:25], 0
    v_dot2c_f32_bf16 v7, v100, v140
    v_dot2c_f32_bf16 v7, v101, v141
    v_dot2c_f32_bf16 v7, v102, v142
    v_dot2c_f32_bf16 v7, v103, v143
    v_dot2c_f32_bf16 v7, v104, v144
    v_dot2c_f32_bf16 v7, v105, v145
    v_dot2c_f32_bf16 v7, v106, v146
    v_dot2c_f32_bf16 v7, v107, v147
    v_dot2c_f32_bf16 v7, v108, v148
    v_dot2c_f32_bf16 v7, v109, v149
    v_dot2c_f32_bf16 v7, v110, v150
    v_dot2c_f32_bf16 v7, v111, v151
    v_dot2c_f32_bf16 v7, v112, v152
    v_dot2c_f32_bf16 v7, v113, v153
    v_dot2c_f32_bf16 v7, v114, v154
    v_dot2c_f32_bf16 v7, v115, v155
    v_dot2c_f32_bf16 v7, v116, v156
    v_dot2c_f32_bf16 v7, v117, v157
    v_dot2c_f32_bf16 v7, v118, v158
    v_dot2c_f32_bf16 v7, v119, v159
    v_dot2c_f32_bf16 v7, v120, v160
    v_dot2c_f32_bf16 v7, v121, v161
    v_dot2c_f32_bf16 v7, v122, v162
    v_dot2c_f32_bf16 v7, v123, v163
    v_dot2c_f32_bf16 v7, v124, v164
    v_dot2c_f32_bf16 v7, v125, v165
    v_dot2c_f32_bf16 v7, v126, v166
    v_dot2c_f32_bf16 v7, v127, v167
    v_dot2c_f32_bf16 v7, v128, v168
    v_dot2c_f32_bf16 v7, v129, v169
    v_dot2c_f32_bf16 v7, v130, v170
    v_dot2c_f32_bf16 v7, v131, v171
    v_dot2c_f32_bf16 v7, v132, v172
    v_dot2c_f32_bf16 v7, v133, v173
    v_dot2c_f32_bf16 v7, v134, v174
    v_dot2c_f32_bf16 v7, v135, v175
    v_dot2c_f32_bf16 v7, v136, v176
    v_dot2c_f32_bf16 v7, v137, v177
    v_dot2c_f32_bf16 v7, v138, v178
    v_dot2c_f32_bf16 v7, v139, v179
    s_nop 2
    v_add_f32_dpp v7, v7, v7 quad_perm:[1,0,3,2] row_mask:0xf bank_mask:0xf
    s_nop 1
    v_add_f32_dpp v7, v7, v7 quad_perm:[2,3,0,1] row_mask:0xf bank_mask:0xf
    s_nop 1
    v_add_f32_dpp v7, v7, v7 row_half_mirror row_mask:0xf bank_mask:0xf
    ds_write_b32 v9, v7
    s_waitcnt lgkmcnt(0)
    s_and_b64 s[76:77], s[76:77], s[78:79]
    s_and_b64 s[80:81], s[80:81], s[82:83]
    s_and_b64 s[76:77], s[76:77], s[80:81]
    s_and_b32 s76, s76, s77
    s_cbranch_scc1 L_COK3
    s_mov_b32 s71, 0
    v_lshlrev_b32 v2, 2, v0
    s_mov_b64 exec, 0xff
L_CLP4:
    s_sleep 16
    buffer_load_dword v3, v2, s[44:47], 0 offen sc1
    s_waitcnt vmcnt(0)
    v_cmp_eq_u32 vcc, 0, v3
    s_cbranch_vccz L_CLP4x
    s_add_u32 s71, s71, 1
    s_cmp_gt_u32 s71, 200000
    s_cbranch_scc0 L_CLP4
L_CLP4x:
    s_mov_b64 exec, -1
L_COK3:
    s_waitcnt vmcnt(0)
    s_barrier
    s_cmp_lg_u32 s3, 3
    s_cbranch_scc1 L_NOPUB2
    v_lshlrev_b32 v2, 2, v0
    v_add_u32 v3, 104448, v2
    ds_read_b32 v7, v3
    s_lshl_b32 s70, s60, 8
    s_add_u32 s70, s70, 5373952
    s_waitcnt lgkmcnt(0)
    buffer_store_dword v7, v2, s[36:39], s70 offen sc1
    s_waitcnt vmcnt(0)
    s_lshl_b32 s70, s48, 5
    s_add_u32 s70, s70, s50
    s_lshl_b32 s70, s70, 7
    s_add_u32 s70, s70, 5439488
    s_lshl_b32 s71, 1, s49
    v_lshlrev_b32 v2, 13, v0
    v_mov_b32 v3, s71
    s_mov_b32 exec_lo, 0xff
    s_mov_b32 exec_hi, 0
    buffer_atomic_or v3, v2, s[36:39], s70 offen sc1
    s_mov_b64 exec, -1
L_NOPUB2:
    s_cmp_ge_u32 s3, 4
    s_cbranch_scc0 L_AUXE
    s_lshl_b32 s70, s51, 3
    s_lshr_b32 s70, 0x3020100, s70
    s_and_b32 s71, s70, 15
    s_mul_i32 s71, s71, 20480
    s_lshr_b32 s70, s70, 4
    s_add_u32 s70, s70, s52
    s_and_b32 s70, s70, 3
    s_mul_i32 s70, s70, 204800
    s_add_u32 s71, s71, s70
    s_mul_i32 s70, s52, 160
    s_add_u32 s71, s71, s70
    s_mul_i32 s70, s51, 5120
    s_add_u32 m0, s70, 0
    s_nop 0
    buffer_load_dwordx4 v72, s[40:43], s71 offen offset:0 lds
    buffer_load_dwordx4 v73, s[40:43], s71 offen offset:1024 lds
    buffer_load_dwordx4 v74, s[40:43], s71 offen offset:2048 lds
    buffer_load_dwordx4 v75, s[40:43], s71 offen offset:3072 lds
    s_add_u32 m0, m0, 4096
    s_nop 0
    buffer_load_dwordx4 v76, s[40:43], s71 offen offset:0 lds
    s_lshl_b32 s70, s51, 3
    s_lshr_b32 s70, 0x20111004, s70
    s_and_b32 s71, s70, 15
    s_mul_i32 s71, s71, 20480
    s_lshr_b32 s70, s70, 4
    s_add_u32 s70, s70, s52
    s_and_b32 s70, s70, 3
    s_mul_i32 s70, s70, 204800
    s_add_u32 s71, s71, s70
    s_mul_i32 s70, s52, 160
    s_add_u32 s71, s71, s70
    s_mul_i32 s70, s51, 5120
    s_add_u32 m0, s70, 20480
    s_nop 0
    buffer_load_dwordx4 v72, s[40:43], s71 offen offset:0 lds
    buffer_load_dwordx4 v73, s[40:43], s71 offen offset:1024 lds
    buffer_load_dwordx4 v74, s[40:43], s71 offen offset:2048 lds
    buffer_load_dwordx4 v75, s[40:43], s71 offen offset:3072 lds
    s_add_u32 m0, m0, 4096
    s_nop 0
    buffer_load_dwordx4 v76, s[40:43], s71 offen offset:0 lds
    s_lshl_b32 s70, s51, 3
    s_lshr_b32 s70, 0x24232221, s70
    s_and_b32 s71, s70, 15
    s_mul_i32 s71, s71, 20480
    s_lshr_b32 s70, s70, 4
    s_add_u32 s70, s70, s52
    s_and_b32 s70, s70, 3
    s_mul_i32 s70, s70, 204800
    s_add_u32 s71, s71, s70
    s_mul_i32 s70, s52, 160
    s_add_u32 s71, s71, s70
    s_mul_i32 s70, s51, 5120
    s_add_u32 m0, s70, 40960
    s_nop 0
    buffer_load_dwordx4 v72, s[40:43], s71 offen offset:0 lds
    buffer_load_dwordx4 v73, s[40:43], s71 offen offset:1024 lds
    buffer_load_dwordx4 v74, s[40:43], s71 offen offset:2048 lds
    buffer_load_dwordx4 v75, s[40:43], s71 offen offset:3072 lds
    s_add_u32 m0, m0, 4096
    s_nop 0
    buffer_load_dwordx4 v76, s[40:43], s71 offen offset:0 lds
    s_lshl_b32 s70, s51, 3
    s_lshr_b32 s70, 0x13123130, s70
    s_and_b32 s71, s70, 15
    s_mul_i32 s71, s71, 20480
    s_lshr_b32 s70, s70, 4
    s_add_u32 s70, s70, s52
    s_and_b32 s70, s70, 3
    s_mul_i32 s70, s70, 204800
    s_add_u32 s71, s71, s70
    s_mul_i32 s70, s52, 160
    s_add_u32 s71, s71, s70
    s_mul_i32 s70, s51, 5120
    s_add_u32 m0, s70, 61440
    s_nop 0
    buffer_load_dwordx4 v72, s[40:43], s71 offen offset:0 lds
    buffer_load_dwordx4 v73, s[40:43], s71 offen offset:1024 lds
    buffer_load_dwordx4 v74, s[40:43], s71 offen offset:2048 lds
    buffer_load_dwordx4 v75, s[40:43], s71 offen offset:3072 lds
    s_add_u32 m0, m0, 4096
    s_nop 0
    buffer_load_dwordx4 v76, s[40:43], s71 offen offset:0 lds
    s_lshl_b32 s70, s51, 3
    s_lshr_b32 s70, 0x34333214, s70
    s_and_b32 s71, s70, 15
    s_mul_i32 s71, s71, 20480
    s_lshr_b32 s70, s70, 4
    s_add_u32 s70, s70, s52
    s_and_b32 s70, s70, 3
    s_mul_i32 s70, s70, 204800
    s_add_u32 s71, s71, s70
    s_mul_i32 s70, s52, 160
    s_add_u32 s71, s71, s70
    s_mul_i32 s70, s51, 5120
    s_add_u32 m0, s70, 81920
    s_nop 0
    buffer_load_dwordx4 v72, s[40:43], s71 offen offset:0 lds
    buffer_load_dwordx4 v73, s[40:43], s71 offen offset:1024 lds
    buffer_load_dwordx4 v74, s[40:43], s71 offen offset:2048 lds
    buffer_load_dwordx4 v75, s[40:43], s71 offen offset:3072 lds
    s_add_u32 m0, m0, 4096
    s_nop 0
    buffer_load_dwordx4 v76, s[40:43], s71 offen offset:0 lds
    s_branch L_P2H
L_AUXE:
    s_barrier
    s_branch L_P2
L_DFT:
    s_cmp_ge_u32 s3, 4
    s_cbranch_scc0 L_DCOMP
    s_sub_u32 s56, s50, 24
    s_lshl_b32 s57, s56, 3
    s_lshl_b32 s70, s51, 1
    s_add_u32 s57, s57, s70
    s_add_u32 s57, s57, s48
    v_lshrrev_b32 v2, 3, v0
    v_and_b32 v3, 7, v0
    s_mul_i32 s60, s57, 1280
    s_lshl_b32 s61, s51, 12
    v_add_u32 v4, 0, v2
    v_mul_u32_u24 v8, 81920, v4
    v_bfe_u32 v4, v4, 1, 3
    v_xor_b32 v4, v4, v3
    v_lshl_add_u32 v8, v4, 4, v8
    v_add_u32 v4, 8, v2
    v_mul_u32_u24 v9, 81920, v4
    v_bfe_u32 v4, v4, 1, 3
    v_xor_b32 v4, v4, v3
    v_lshl_add_u32 v9, v4, 4, v9
    v_subrev_u32 v9, 1024, v9
    v_add_u32 v4, 16, v2
    v_mul_u32_u24 v10, 81920, v4
    v_bfe_u32 v4, v4, 1, 3
    v_xor_b32 v4, v4, v3
    v_lshl_add_u32 v10, v4, 4, v10
    v_subrev_u32 v10, 2048, v10
    v_add_u32 v4, 24, v2
    v_mul_u32_u24 v11, 81920, v4
    v_bfe_u32 v4, v4, 1, 3
    v_xor_b32 v4, v4, v3
    v_lshl_add_u32 v11, v4, 4, v11
    v_subrev_u32 v11, 3072, v11
    s_lshr_b32 s58, s49, 1
    s_mul_i32 s58, s58, 160
    s_and_b32 s70, s49, 1
    s_add_u32 s58, s58, s70
    s_mul_i32 s59, s51, 20
    s_or_b32 s70, s49, s51
    s_cmp_eq_u32 s70, 0
    s_cselect_b32 s62, 0xff, 0
    s_mov_b32 s63, 0
    v_mov_b32 v22, 0xbf803f80
    v_mov_b32 v23, v22
    s_mul_i32 s70, s51, 2560
    s_add_u32 s70, s70, 32768
    v_lshlrev_b32 v18, 4, v0
    v_add_u32 v18, s70, v18
    v_add_u32 v19, 53248, v18
    v_add_u32 v20, 106496, v18
    v_add_u32 v2, s59, v2
    v_add_u32 v4, 0, v2
    v_lshl_add_u32 v12, v4, 1, s58
    v_cvt_f32_u32 v12, v12
    v_mul_f32 v12, 0xbacccccd, v12
    v_bfe_u32 v4, v4, 1, 3
    v_xor_b32 v4, v4, v3
    v_lshlrev_b32 v4, 3, v4
    v_cvt_f32_u32 v4, v4
    v_mul_f32 v15, v4, v12
    v_add_u32 v4, 8, v2
    v_lshl_add_u32 v13, v4, 1, s58
    v_cvt_f32_u32 v13, v13
    v_mul_f32 v13, 0xbacccccd, v13
    v_bfe_u32 v4, v4, 1, 3
    v_xor_b32 v4, v4, v3
    v_lshlrev_b32 v4, 3, v4
    v_cvt_f32_u32 v4, v4
    v_mul_f32 v16, v4, v13
    v_add_u32 v4, 16, v2
    v_lshl_add_u32 v14, v4, 1, s58
    v_cvt_f32_u32 v14, v14
    v_mul_f32 v14, 0xbacccccd, v14
    v_bfe_u32 v4, v4, 1, 3
    v_xor_b32 v4, v4, v3
    v_lshlrev_b32 v4, 3, v4
    v_cvt_f32_u32 v4, v4
    v_mul_f32 v17, v4, v14
    s_waitcnt lgkmcnt(0)
    s_mov_b32 s28, s4
    s_mov_b32 s29, s5
    s_mov_b32 s30, 2621440
    s_mov_b32 s31, 0x20000
    s_add_u32 m0, s61, 53248
    s_add_u32 s58, s60, 0
    buffer_load_dwordx4 v8, s[28:31], s58 offen offset:0 lds
    buffer_load_dwordx4 v9, s[28:31], s58 offen offset:1024 lds
    buffer_load_dwordx4 v10, s[28:31], s58 offen offset:2048 lds
    buffer_load_dwordx4 v11, s[28:31], s58 offen offset:3072 lds
    s_add_u32 m0, s61, 69632
    s_add_u32 s58, s60, 640
    buffer_load_dwordx4 v8, s[28:31], s58 offen offset:0 lds
    buffer_load_dwordx4 v9, s[28:31], s58 offen offset:1024 lds
    buffer_load_dwordx4 v10, s[28:31], s58 offen offset:2048 lds
    buffer_load_dwordx4 v11, s[28:31], s58 offen offset:3072 lds
    v_fmamk_f32 v158, v12, 0x0, v15
    v_fmamk_f32 v159, v12, 0x3f800000, v15
    v_fmamk_f32 v160, v12, 0x40000000, v15
    v_fmamk_f32 v161, v12, 0x40400000, v15
    v_fmamk_f32 v162, v12, 0x40800000, v15
    v_fmamk_f32 v163, v12, 0x40a00000, v15
    v_fmamk_f32 v164, v12, 0x40c00000, v15
    v_fmamk_f32 v165, v12, 0x40e00000, v15
    v_mul_f32 v202, 0x42800000, v12
    v_cos_f32 v150, v158
    v_sin_f32 v158, v158
    v_cos_f32 v151, v159
    v_sin_f32 v159, v159
    v_cos_f32 v152, v160
    v_sin_f32 v160, v160
    v_cos_f32 v153, v161
    v_sin_f32 v161, v161
    v_cos_f32 v154, v162
    v_sin_f32 v162, v162
    v_cos_f32 v155, v163
    v_sin_f32 v163, v163
    v_cos_f32 v156, v164
    v_sin_f32 v164, v164
    v_cos_f32 v157, v165
    v_sin_f32 v165, v165
    v_cos_f32 v200, v202
    v_sin_f32 v202, v202
    v_cvt_pk_bf16_f32 v100, v150, v151
    v_cvt_pk_bf16_f32 v101, v152, v153
    v_cvt_pk_bf16_f32 v102, v154, v155
    v_cvt_pk_bf16_f32 v103, v156, v157
    v_cvt_pk_bf16_f32 v104, v158, v159
    v_cvt_pk_bf16_f32 v105, v160, v161
    v_cvt_pk_bf16_f32 v106, v162, v163
    v_cvt_pk_bf16_f32 v107, v164, v165
    v_fmamk_f32 v174, v13, 0x0, v16
    v_fmamk_f32 v175, v13, 0x3f800000, v16
    v_fmamk_f32 v176, v13, 0x40000000, v16
    v_fmamk_f32 v177, v13, 0x40400000, v16
    v_fmamk_f32 v178, v13, 0x40800000, v16
    v_fmamk_f32 v179, v13, 0x40a00000, v16
    v_fmamk_f32 v180, v13, 0x40c00000, v16
    v_fmamk_f32 v181, v13, 0x40e00000, v16
    v_mul_f32 v206, 0x42800000, v13
    v_cos_f32 v166, v174
    v_sin_f32 v174, v174
    v_cos_f32 v167, v175
    v_sin_f32 v175, v175
    v_cos_f32 v168, v176
    v_sin_f32 v176, v176
    v_cos_f32 v169, v177
    v_sin_f32 v177, v177
    v_cos_f32 v170, v178
    v_sin_f32 v178, v178
    v_cos_f32 v171, v179
    v_sin_f32 v179, v179
    v_cos_f32 v172, v180
    v_sin_f32 v180, v180
    v_cos_f32 v173, v181
    v_sin_f32 v181, v181
    v_cos_f32 v204, v206
    v_sin_f32 v206, v206
    v_cvt_pk_bf16_f32 v108, v166, v167
    v_cvt_pk_bf16_f32 v109, v168, v169
    v_cvt_pk_bf16_f32 v110, v170, v171
    v_cvt_pk_bf16_f32 v111, v172, v173
    v_cvt_pk_bf16_f32 v112, v174, v175
    v_cvt_pk_bf16_f32 v113, v176, v177
    v_cvt_pk_bf16_f32 v114, v178, v179
    v_cvt_pk_bf16_f32 v115, v180, v181
    v_fmamk_f32 v190, v14, 0x0, v17
    v_fmamk_f32 v191, v14, 0x3f800000, v17
    v_fmamk_f32 v192, v14, 0x40000000, v17
    v_fmamk_f32 v193, v14, 0x40400000, v17
    v_fmamk_f32 v194, v14, 0x40800000, v17
    v_fmamk_f32 v195, v14, 0x40a00000, v17
    v_fmamk_f32 v196, v14, 0x40c00000, v17
    v_fmamk_f32 v197, v14, 0x40e00000, v17
    v_mul_f32 v210, 0x42800000, v14
    v_cos_f32 v182, v190
    v_sin_f32 v190, v190
    v_cos_f32 v183, v191
    v_sin_f32 v191, v191
    v_cos_f32 v184, v192
    v_sin_f32 v192, v192
    v_cos_f32 v185, v193
    v_sin_f32 v193, v193
    v_cos_f32 v186, v194
    v_sin_f32 v194, v194
    v_cos_f32 v187, v195
    v_sin_f32 v195, v195
    v_cos_f32 v188, v196
    v_sin_f32 v196, v196
    v_cos_f32 v189, v197
    v_sin_f32 v197, v197
    v_cos_f32 v208, v210
    v_sin_f32 v210, v210
    v_cvt_pk_bf16_f32 v116, v182, v183
    v_cvt_pk_bf16_f32 v117, v184, v185
    v_cvt_pk_bf16_f32 v118, v186, v187
    v_cvt_pk_bf16_f32 v119, v188, v189
    v_cvt_pk_bf16_f32 v120, v190, v191
    v_cvt_pk_bf16_f32 v121, v192, v193
    v_cvt_pk_bf16_f32 v122, v194, v195
    v_cvt_pk_bf16_f32 v123, v196, v197
    s_mov_b64 exec, s[62:63]
    v_pk_mov_b32 v[104:105], v[22:23], v[22:23]
    v_pk_mov_b32 v[106:107], v[22:23], v[22:23]
    s_mov_b64 exec, -1
    ds_write_b128 v19, v[100:103] offset:0
    ds_write_b128 v19, v[104:107] offset:10240
    ds_write_b128 v19, v[108:111] offset:1024
    ds_write_b128 v19, v[112:115] offset:11264
    s_mov_b32 exec_hi, 0
    ds_write_b128 v19, v[116:119] offset:2048
    ds_write_b128 v19, v[120:123] offset:12288
    s_mov_b32 exec_hi, -1
    v_pk_mul_f32 v[24:25], v[158:159], v[202:203] op_sel_hi:[1,0]
    v_pk_mul_f32 v[32:33], v[150:151], v[202:203] op_sel_hi:[1,0]
    v_pk_mul_f32 v[26:27], v[160:161], v[202:203] op_sel_hi:[1,0]
    v_pk_mul_f32 v[34:35], v[152:153], v[202:203] op_sel_hi:[1,0]
    v_pk_mul_f32 v[28:29], v[162:163], v[202:203] op_sel_hi:[1,0]
    v_pk_mul_f32 v[36:37], v[154:155], v[202:203] op_sel_hi:[1,0]
    v_pk_mul_f32 v[30:31], v[164:165], v[202:203] op_sel_hi:[1,0]
    v_pk_mul_f32 v[38:39], v[156:157], v[202:203] op_sel_hi:[1,0]
    v_pk_fma_f32 v[150:151], v[150:151], v[200:201], v[24:25] op_sel_hi:[1,0,1] neg_lo:[0,0,1] neg_hi:[0,0,1]
    v_pk_fma_f32 v[158:159], v[158:159], v[200:201], v[32:33] op_sel_hi:[1,0,1]
    v_pk_fma_f32 v[152:153], v[152:153], v[200:201], v[26:27] op_sel_hi:[1,0,1] neg_lo:[0,0,1] neg_hi:[0,0,1]
    v_pk_fma_f32 v[160:161], v[160:161], v[200:201], v[34:35] op_sel_hi:[1,0,1]
    v_pk_fma_f32 v[154:155], v[154:155], v[200:201], v[28:29] op_sel_hi:[1,0,1] neg_lo:[0,0,1] neg_hi:[0,0,1]
    v_pk_fma_f32 v[162:163], v[162:163], v[200:201], v[36:37] op_sel_hi:[1,0,1]
    v_pk_fma_f32 v[156:157], v[156:157], v[200:201], v[30:31] op_sel_hi:[1,0,1] neg_lo:[0,0,1] neg_hi:[0,0,1]
    v_pk_fma_f32 v[164:165], v[164:165], v[200:201], v[38:39] op_sel_hi:[1,0,1]
    v_cvt_pk_bf16_f32 v124, v150, v151
    v_cvt_pk_bf16_f32 v125, v152, v153
    v_cvt_pk_bf16_f32 v126, v154, v155
    v_cvt_pk_bf16_f32 v127, v156, v157
    v_cvt_pk_bf16_f32 v128, v158, v159
    v_cvt_pk_bf16_f32 v129, v160, v161
    v_cvt_pk_bf16_f32 v130, v162, v163
    v_cvt_pk_bf16_f32 v131, v164, v165
    v_pk_mul_f32 v[24:25], v[174:175], v[206:207] op_sel_hi:[1,0]
    v_pk_mul_f32 v[32:33], v[166:167], v[206:207] op_sel_hi:[1,0]
    v_pk_mul_f32 v[26:27], v[176:177], v[206:207] op_sel_hi:[1,0]
    v_pk_mul_f32 v[34:35], v[168:169], v[206:207] op_sel_hi:[1,0]
    v_pk_mul_f32 v[28:29], v[178:179], v[206:207] op_sel_hi:[1,0]
    v_pk_mul_f32 v[36:37], v[170:171], v[206:207] op_sel_hi:[1,0]
    v_pk_mul_f32 v[30:31], v[180:181], v[206:207] op_sel_hi:[1,0]
    v_pk_mul_f32 v[38:39], v[172:173], v[206:207] op_sel_hi:[1,0]
    v_pk_fma_f32 v[166:167], v[166:167], v[204:205], v[24:25] op_sel_hi:[1,0,1] neg_lo:[0,0,1] neg_hi:[0,0,1]
    v_pk_fma_f32 v[174:175], v[174:175], v[204:205], v[32:33] op_sel_hi:[1,0,1]
    v_pk_fma_f32 v[168:169], v[168:169], v[204:205], v[26:27] op_sel_hi:[1,0,1] neg_lo:[0,0,1] neg_hi:[0,0,1]
    v_pk_fma_f32 v[176:177], v[176:177], v[204:205], v[34:35] op_sel_hi:[1,0,1]
    v_pk_fma_f32 v[170:171], v[170:171], v[204:205], v[28:29] op_sel_hi:[1,0,1] neg_lo:[0,0,1] neg_hi:[0,0,1]
    v_pk_fma_f32 v[178:179], v[178:179], v[204:205], v[36:37] op_sel_hi:[1,0,1]
    v_pk_fma_f32 v[172:173], v[172:173], v[204:205], v[30:31] op_sel_hi:[1,0,1] neg_lo:[0,0,1] neg_hi:[0,0,1]
    v_pk_fma_f32 v[180:181], v[180:181], v[204:205], v[38:39] op_sel_hi:[1,0,1]
    v_cvt_pk_bf16_f32 v132, v166, v167
    v_cvt_pk_bf16_f32 v133, v168, v169
    v_cvt_pk_bf16_f32 v134, v170, v171
    v_cvt_pk_bf16_f32 v135, v172, v173
    v_cvt_pk_bf16_f32 v136, v174, v175
    v_cvt_pk_bf16_f32 v137, v176, v177
    v_cvt_pk_bf16_f32 v138, v178, v179
    v_cvt_pk_bf16_f32 v139, v180, v181
    v_pk_mul_f32 v[24:25], v[190:191], v[210:211] op_sel_hi:[1,0]
    v_pk_mul_f32 v[32:33], v[182:183], v[210:211] op_sel_hi:[1,0]
    v_pk_mul_f32 v[26:27], v[192:193], v[210:211] op_sel_hi:[1,0]
    v_pk_mul_f32 v[34:35], v[184:185], v[210:211] op_sel_hi:[1,0]
    v_pk_mul_f32 v[28:29], v[194:195], v[210:211] op_sel_hi:[1,0]
    v_pk_mul_f32 v[36:37], v[186:187], v[210:211] op_sel_hi:[1,0]
    v_pk_mul_f32 v[30:31], v[196:197], v[210:211] op_sel_hi:[1,0]
    v_pk_mul_f32 v[38:39], v[188:189], v[210:211] op_sel_hi:[1,0]
    v_pk_fma_f32 v[182:183], v[182:183], v[208:209], v[24:25] op_sel_hi:[1,0,1] neg_lo:[0,0,1] neg_hi:[0,0,1]
    v_pk_fma_f32 v[190:191], v[190:191], v[208:209], v[32:33] op_sel_hi:[1,0,1]
    v_pk_fma_f32 v[184:185], v[184:185], v[208:209], v[26:27] op_sel_hi:[1,0,1] neg_lo:[0,0,1] neg_hi:[0,0,1]
    v_pk_fma_f32 v[192:193], v[192:193], v[208:209], v[34:35] op_sel_hi:[1,0,1]
    v_pk_fma_f32 v[186:187], v[186:187], v[208:209], v[28:29] op_sel_hi:[1,0,1] neg_lo:[0,0,1] neg_hi:[0,0,1]
    v_pk_fma_f32 v[194:195], v[194:195], v[208:209], v[36:37] op_sel_hi:[1,0,1]
    v_pk_fma_f32 v[188:189], v[188:189], v[208:209], v[30:31] op_sel_hi:[1,0,1] neg_lo:[0,0,1] neg_hi:[0,0,1]
    v_pk_fma_f32 v[196:197], v[196:197], v[208:209], v[38:39] op_sel_hi:[1,0,1]
    v_cvt_pk_bf16_f32 v140, v182, v183
    v_cvt_pk_bf16_f32 v141, v184, v185
    v_cvt_pk_bf16_f32 v142, v186, v187
    v_cvt_pk_bf16_f32 v143, v188, v189
    v_cvt_pk_bf16_f32 v144, v190, v191
    v_cvt_pk_bf16_f32 v145, v192, v193
    v_cvt_pk_bf16_f32 v146, v194, v195
    v_cvt_pk_bf16_f32 v147, v196, v197
    s_mov_b64 exec, s[62:63]
    v_pk_mov_b32 v[128:129], v[22:23], v[22:23]
    v_pk_mov_b32 v[130:131], v[22:23], v[22:23]
    s_mov_b64 exec, -1
    ds_write_b128 v20, v[124:127] offset:0
    ds_write_b128 v20, v[128:131] offset:10240
    ds_write_b128 v20, v[132:135] offset:1024
    ds_write_b128 v20, v[136:139] offset:11264
    s_mov_b32 exec_hi, 0
    ds_write_b128 v20, v[140:143] offset:2048
    ds_write_b128 v20, v[144:147] offset:12288
    s_mov_b32 exec_hi, -1
    v_pk_mul_f32 v[24:25], v[158:159], v[202:203] op_sel_hi:[1,0]
    v_pk_mul_f32 v[32:33], v[150:151], v[202:203] op_sel_hi:[1,0]
    v_pk_mul_f32 v[26:27], v[160:161], v[202:203] op_sel_hi:[1,0]
    v_pk_mul_f32 v[34:35], v[152:153], v[202:203] op_sel_hi:[1,0]
    v_pk_mul_f32 v[28:29], v[162:163], v[202:203] op_sel_hi:[1,0]
    v_pk_mul_f32 v[36:37], v[154:155], v[202:203] op_sel_hi:[1,0]
    v_pk_mul_f32 v[30:31], v[164:165], v[202:203] op_sel_hi:[1,0]
    v_pk_mul_f32 v[38:39], v[156:157], v[202:203] op_sel_hi:[1,0]
    v_pk_fma_f32 v[150:151], v[150:151], v[200:201], v[24:25] op_sel_hi:[1,0,1] neg_lo:[0,0,1] neg_hi:[0,0,1]
    v_pk_fma_f32 v[158:159], v[158:159], v[200:201], v[32:33] op_sel_hi:[1,0,1]
    v_pk_fma_f32 v[152:153], v[152:153], v[200:201], v[26:27] op_sel_hi:[1,0,1] neg_lo:[0,0,1] neg_hi:[0,0,1]
    v_pk_fma_f32 v[160:161], v[160:161], v[200:201], v[34:35] op_sel_hi:[1,0,1]
    v_pk_fma_f32 v[154:155], v[154:155], v[200:201], v[28:29] op_sel_hi:[1,0,1] neg_lo:[0,0,1] neg_hi:[0,0,1]
    v_pk_fma_f32 v[162:163], v[162:163], v[200:201], v[36:37] op_sel_hi:[1,0,1]
    v_pk_fma_f32 v[156:157], v[156:157], v[200:201], v[30:31] op_sel_hi:[1,0,1] neg_lo:[0,0,1] neg_hi:[0,0,1]
    v_pk_fma_f32 v[164:165], v[164:165], v[200:201], v[38:39] op_sel_hi:[1,0,1]
    v_cvt_pk_bf16_f32 v100, v150, v151
    v_cvt_pk_bf16_f32 v101, v152, v153
    v_cvt_pk_bf16_f32 v102, v154, v155
    v_cvt_pk_bf16_f32 v103, v156, v157
    v_cvt_pk_bf16_f32 v104, v158, v159
    v_cvt_pk_bf16_f32 v105, v160, v161
    v_cvt_pk_bf16_f32 v106, v162, v163
    v_cvt_pk_bf16_f32 v107, v164, v165
    v_pk_mul_f32 v[24:25], v[174:175], v[206:207] op_sel_hi:[1,0]
    v_pk_mul_f32 v[32:33], v[166:167], v[206:207] op_sel_hi:[1,0]
    v_pk_mul_f32 v[26:27], v[176:177], v[206:207] op_sel_hi:[1,0]
    v_pk_mul_f32 v[34:35], v[168:169], v[206:207] op_sel_hi:[1,0]
    v_pk_mul_f32 v[28:29], v[178:179], v[206:207] op_sel_hi:[1,0]
    v_pk_mul_f32 v[36:37], v[170:171], v[206:207] op_sel_hi:[1,0]
    v_pk_mul_f32 v[30:31], v[180:181], v[206:207] op_sel_hi:[1,0]
    v_pk_mul_f32 v[38:39], v[172:173], v[206:207] op_sel_hi:[1,0]
    v_pk_fma_f32 v[166:167], v[166:167], v[204:205], v[24:25] op_sel_hi:[1,0,1] neg_lo:[0,0,1] neg_hi:[0,0,1]
    v_pk_fma_f32 v[174:175], v[174:175], v[204:205], v[32:33] op_sel_hi:[1,0,1]
    v_pk_fma_f32 v[168:169], v[168:169], v[204:205], v[26:27] op_sel_hi:[1,0,1] neg_lo:[0,0,1] neg_hi:[0,0,1]
    v_pk_fma_f32 v[176:177], v[176:177], v[204:205], v[34:35] op_sel_hi:[1,0,1]
    v_pk_fma_f32 v[170:171], v[170:171], v[204:205], v[28:29] op_sel_hi:[1,0,1] neg_lo:[0,0,1] neg_hi:[0,0,1]
    v_pk_fma_f32 v[178:179], v[178:179], v[204:205], v[36:37] op_sel_hi:[1,0,1]
    v_pk_fma_f32 v[172:173], v[172:173], v[204:205], v[30:31] op_sel_hi:[1,0,1] neg_lo:[0,0,1] neg_hi:[0,0,1]
    v_pk_fma_f32 v[180:181], v[180:181], v[204:205], v[38:39] op_sel_hi:[1,0,1]
    v_cvt_pk_bf16_f32 v108, v166, v167
    v_cvt_pk_bf16_f32 v109, v168, v169
    v_cvt_pk_bf16_f32 v110, v170, v171
    v_cvt_pk_bf16_f32 v111, v172, v173
    v_cvt_pk_bf16_f32 v112, v174, v175
    v_cvt_pk_bf16_f32 v113, v176, v177
    v_cvt_pk_bf16_f32 v114, v178, v179
    v_cvt_pk_bf16_f32 v115, v180, v181
    v_pk_mul_f32 v[24:25], v[190:191], v[210:211] op_sel_hi:[1,0]
    v_pk_mul_f32 v[32:33], v[182:183], v[210:211] op_sel_hi:[1,0]
    v_pk_mul_f32 v[26:27], v[192:193], v[210:211] op_sel_hi:[1,0]
    v_pk_mul_f32 v[34:35], v[184:185], v[210:211] op_sel_hi:[1,0]
    v_pk_mul_f32 v[28:29], v[194:195], v[210:211] op_sel_hi:[1,0]
    v_pk_mul_f32 v[36:37], v[186:187], v[210:211] op_sel_hi:[1,0]
    v_pk_mul_f32 v[30:31], v[196:197], v[210:211] op_sel_hi:[1,0]
    v_pk_mul_f32 v[38:39], v[188:189], v[210:211] op_sel_hi:[1,0]
    v_pk_fma_f32 v[182:183], v[182:183], v[208:209], v[24:25] op_sel_hi:[1,0,1] neg_lo:[0,0,1] neg_hi:[0,0,1]
    v_pk_fma_f32 v[190:191], v[190:191], v[208:209], v[32:33] op_sel_hi:[1,0,1]
    v_pk_fma_f32 v[184:185], v[184:185], v[208:209], v[26:27] op_sel_hi:[1,0,1] neg_lo:[0,0,1] neg_hi:[0,0,1]
    v_pk_fma_f32 v[192:193], v[192:193], v[208:209], v[34:35] op_sel_hi:[1,0,1]
    v_pk_fma_f32 v[186:187], v[186:187], v[208:209], v[28:29] op_sel_hi:[1,0,1] neg_lo:[0,0,1] neg_hi:[0,0,1]
    v_pk_fma_f32 v[194:195], v[194:195], v[208:209], v[36:37] op_sel_hi:[1,0,1]
    v_pk_fma_f32 v[188:189], v[188:189], v[208:209], v[30:31] op_sel_hi:[1,0,1] neg_lo:[0,0,1] neg_hi:[0,0,1]
    v_pk_fma_f32 v[196:197], v[196:197], v[208:209], v[38:39] op_sel_hi:[1,0,1]
    v_cvt_pk_bf16_f32 v116, v182, v183
    v_cvt_pk_bf16_f32 v117, v184, v185
    v_cvt_pk_bf16_f32 v118, v186, v187
    v_cvt_pk_bf16_f32 v119, v188, v189
    v_cvt_pk_bf16_f32 v120, v190, v191
    v_cvt_pk_bf16_f32 v121, v192, v193
    v_cvt_pk_bf16_f32 v122, v194, v195
    v_cvt_pk_bf16_f32 v123, v196, v197
    s_mov_b64 exec, s[62:63]
    v_pk_mov_b32 v[104:105], v[22:23], v[22:23]
    v_pk_mov_b32 v[106:107], v[22:23], v[22:23]
    s_mov_b64 exec, -1
    ds_write_b128 v18, v[100:103] offset:0
    ds_write_b128 v18, v[104:107] offset:10240
    ds_write_b128 v18, v[108:111] offset:1024
    ds_write_b128 v18, v[112:115] offset:11264
    s_mov_b32 exec_hi, 0
    ds_write_b128 v18, v[116:119] offset:2048
    ds_write_b128 v18, v[120:123] offset:12288
    s_mov_b32 exec_hi, -1
    v_pk_mul_f32 v[24:25], v[158:159], v[202:203] op_sel_hi:[1,0]
    v_pk_mul_f32 v[32:33], v[150:151], v[202:203] op_sel_hi:[1,0]
    v_pk_mul_f32 v[26:27], v[160:161], v[202:203] op_sel_hi:[1,0]
    v_pk_mul_f32 v[34:35], v[152:153], v[202:203] op_sel_hi:[1,0]
    v_pk_mul_f32 v[28:29], v[162:163], v[202:203] op_sel_hi:[1,0]
    v_pk_mul_f32 v[36:37], v[154:155], v[202:203] op_sel_hi:[1,0]
    v_pk_mul_f32 v[30:31], v[164:165], v[202:203] op_sel_hi:[1,0]
    v_pk_mul_f32 v[38:39], v[156:157], v[202:203] op_sel_hi:[1,0]
    v_pk_fma_f32 v[150:151], v[150:151], v[200:201], v[24:25] op_sel_hi:[1,0,1] neg_lo:[0,0,1] neg_hi:[0,0,1]
    v_pk_fma_f32 v[158:159], v[158:159], v[200:201], v[32:33] op_sel_hi:[1,0,1]
    v_pk_fma_f32 v[152:153], v[152:153], v[200:201], v[26:27] op_sel_hi:[1,0,1] neg_lo:[0,0,1] neg_hi:[0,0,1]
    v_pk_fma_f32 v[160:161], v[160:161], v[200:201], v[34:35] op_sel_hi:[1,0,1]
    v_pk_fma_f32 v[154:155], v[154:155], v[200:201], v[28:29] op_sel_hi:[1,0,1] neg_lo:[0,0,1] neg_hi:[0,0,1]
    v_pk_fma_f32 v[162:163], v[162:163], v[200:201], v[36:37] op_sel_hi:[1,0,1]
    v_pk_fma_f32 v[156:157], v[156:157], v[200:201], v[30:31] op_sel_hi:[1,0,1] neg_lo:[0,0,1] neg_hi:[0,0,1]
    v_pk_fma_f32 v[164:165], v[164:165], v[200:201], v[38:39] op_sel_hi:[1,0,1]
    v_cvt_pk_bf16_f32 v124, v150, v151
    v_cvt_pk_bf16_f32 v125, v152, v153
    v_cvt_pk_bf16_f32 v126, v154, v155
    v_cvt_pk_bf16_f32 v127, v156, v157
    v_cvt_pk_bf16_f32 v128, v158, v159
    v_cvt_pk_bf16_f32 v129, v160, v161
    v_cvt_pk_bf16_f32 v130, v162, v163
    v_cvt_pk_bf16_f32 v131, v164, v165
    v_pk_mul_f32 v[24:25], v[174:175], v[206:207] op_sel_hi:[1,0]
    v_pk_mul_f32 v[32:33], v[166:167], v[206:207] op_sel_hi:[1,0]
    v_pk_mul_f32 v[26:27], v[176:177], v[206:207] op_sel_hi:[1,0]
    v_pk_mul_f32 v[34:35], v[168:169], v[206:207] op_sel_hi:[1,0]
    v_pk_mul_f32 v[28:29], v[178:179], v[206:207] op_sel_hi:[1,0]
    v_pk_mul_f32 v[36:37], v[170:171], v[206:207] op_sel_hi:[1,0]
    v_pk_mul_f32 v[30:31], v[180:181], v[206:207] op_sel_hi:[1,0]
    v_pk_mul_f32 v[38:39], v[172:173], v[206:207] op_sel_hi:[1,0]
    v_pk_fma_f32 v[166:167], v[166:167], v[204:205], v[24:25] op_sel_hi:[1,0,1] neg_lo:[0,0,1] neg_hi:[0,0,1]
    v_pk_fma_f32 v[174:175], v[174:175], v[204:205], v[32:33] op_sel_hi:[1,0,1]
    v_pk_fma_f32 v[168:169], v[168:169], v[204:205], v[26:27] op_sel_hi:[1,0,1] neg_lo:[0,0,1] neg_hi:[0,0,1]
    v_pk_fma_f32 v[176:177], v[176:177], v[204:205], v[34:35] op_sel_hi:[1,0,1]
    v_pk_fma_f32 v[170:171], v[170:171], v[204:205], v[28:29] op_sel_hi:[1,0,1] neg_lo:[0,0,1] neg_hi:[0,0,1]
    v_pk_fma_f32 v[178:179], v[178:179], v[204:205], v[36:37] op_sel_hi:[1,0,1]
    v_pk_fma_f32 v[172:173], v[172:173], v[204:205], v[30:31] op_sel_hi:[1,0,1] neg_lo:[0,0,1] neg_hi:[0,0,1]
    v_pk_fma_f32 v[180:181], v[180:181], v[204:205], v[38:39] op_sel_hi:[1,0,1]
    v_cvt_pk_bf16_f32 v132, v166, v167
    v_cvt_pk_bf16_f32 v133, v168, v169
    v_cvt_pk_bf16_f32 v134, v170, v171
    v_cvt_pk_bf16_f32 v135, v172, v173
    v_cvt_pk_bf16_f32 v136, v174, v175
    v_cvt_pk_bf16_f32 v137, v176, v177
    v_cvt_pk_bf16_f32 v138, v178, v179
    v_cvt_pk_bf16_f32 v139, v180, v181
    v_pk_mul_f32 v[24:25], v[190:191], v[210:211] op_sel_hi:[1,0]
    v_pk_mul_f32 v[32:33], v[182:183], v[210:211] op_sel_hi:[1,0]
    v_pk_mul_f32 v[26:27], v[192:193], v[210:211] op_sel_hi:[1,0]
    v_pk_mul_f32 v[34:35], v[184:185], v[210:211] op_sel_hi:[1,0]
    v_pk_mul_f32 v[28:29], v[194:195], v[210:211] op_sel_hi:[1,0]
    v_pk_mul_f32 v[36:37], v[186:187], v[210:211] op_sel_hi:[1,0]
    v_pk_mul_f32 v[30:31], v[196:197], v[210:211] op_sel_hi:[1,0]
    v_pk_mul_f32 v[38:39], v[188:189], v[210:211] op_sel_hi:[1,0]
    v_pk_fma_f32 v[182:183], v[182:183], v[208:209], v[24:25] op_sel_hi:[1,0,1] neg_lo:[0,0,1] neg_hi:[0,0,1]
    v_pk_fma_f32 v[190:191], v[190:191], v[208:209], v[32:33] op_sel_hi:[1,0,1]
    v_pk_fma_f32 v[184:185], v[184:185], v[208:209], v[26:27] op_sel_hi:[1,0,1] neg_lo:[0,0,1] neg_hi:[0,0,1]
    v_pk_fma_f32 v[192:193], v[192:193], v[208:209], v[34:35] op_sel_hi:[1,0,1]
    v_pk_fma_f32 v[186:187], v[186:187], v[208:209], v[28:29] op_sel_hi:[1,0,1] neg_lo:[0,0,1] neg_hi:[0,0,1]
    v_pk_fma_f32 v[194:195], v[194:195], v[208:209], v[36:37] op_sel_hi:[1,0,1]
    v_pk_fma_f32 v[188:189], v[188:189], v[208:209], v[30:31] op_sel_hi:[1,0,1] neg_lo:[0,0,1] neg_hi:[0,0,1]
    v_pk_fma_f32 v[196:197], v[196:197], v[208:209], v[38:39] op_sel_hi:[1,0,1]
    v_cvt_pk_bf16_f32 v140, v182, v183
    v_cvt_pk_bf16_f32 v141, v184, v185
    v_cvt_pk_bf16_f32 v142, v186, v187
    v_cvt_pk_bf16_f32 v143, v188, v189
    v_cvt_pk_bf16_f32 v144, v190, v191
    v_cvt_pk_bf16_f32 v145, v192, v193
    v_cvt_pk_bf16_f32 v146, v194, v195
    v_cvt_pk_bf16_f32 v147, v196, v197
    s_mov_b64 exec, s[62:63]
    v_pk_mov_b32 v[128:129], v[22:23], v[22:23]
    v_pk_mov_b32 v[130:131], v[22:23], v[22:23]
    s_mov_b64 exec, -1
    s_waitcnt lgkmcnt(0)
    v_pk_mul_f32 v[24:25], v[158:159], v[202:203] op_sel_hi:[1,0]
    v_pk_mul_f32 v[32:33], v[150:151], v[202:203] op_sel_hi:[1,0]
    v_pk_mul_f32 v[26:27], v[160:161], v[202:203] op_sel_hi:[1,0]
    v_pk_mul_f32 v[34:35], v[152:153], v[202:203] op_sel_hi:[1,0]
    v_pk_mul_f32 v[28:29], v[162:163], v[202:203] op_sel_hi:[1,0]
    v_pk_mul_f32 v[36:37], v[154:155], v[202:203] op_sel_hi:[1,0]
    v_pk_mul_f32 v[30:31], v[164:165], v[202:203] op_sel_hi:[1,0]
    v_pk_mul_f32 v[38:39], v[156:157], v[202:203] op_sel_hi:[1,0]
    v_pk_fma_f32 v[150:151], v[150:151], v[200:201], v[24:25] op_sel_hi:[1,0,1] neg_lo:[0,0,1] neg_hi:[0,0,1]
    v_pk_fma_f32 v[158:159], v[158:159], v[200:201], v[32:33] op_sel_hi:[1,0,1]
    v_pk_fma_f32 v[152:153], v[152:153], v[200:201], v[26:27] op_sel_hi:[1,0,1] neg_lo:[0,0,1] neg_hi:[0,0,1]
    v_pk_fma_f32 v[160:161], v[160:161], v[200:201], v[34:35] op_sel_hi:[1,0,1]
    v_pk_fma_f32 v[154:155], v[154:155], v[200:201], v[28:29] op_sel_hi:[1,0,1] neg_lo:[0,0,1] neg_hi:[0,0,1]
    v_pk_fma_f32 v[162:163], v[162:163], v[200:201], v[36:37] op_sel_hi:[1,0,1]
    v_pk_fma_f32 v[156:157], v[156:157], v[200:201], v[30:31] op_sel_hi:[1,0,1] neg_lo:[0,0,1] neg_hi:[0,0,1]
    v_pk_fma_f32 v[164:165], v[164:165], v[200:201], v[38:39] op_sel_hi:[1,0,1]
    v_cvt_pk_bf16_f32 v100, v150, v151
    v_cvt_pk_bf16_f32 v101, v152, v153
    v_cvt_pk_bf16_f32 v102, v154, v155
    v_cvt_pk_bf16_f32 v103, v156, v157
    v_cvt_pk_bf16_f32 v104, v158, v159
    v_cvt_pk_bf16_f32 v105, v160, v161
    v_cvt_pk_bf16_f32 v106, v162, v163
    v_cvt_pk_bf16_f32 v107, v164, v165
    v_pk_mul_f32 v[24:25], v[174:175], v[206:207] op_sel_hi:[1,0]
    v_pk_mul_f32 v[32:33], v[166:167], v[206:207] op_sel_hi:[1,0]
    v_pk_mul_f32 v[26:27], v[176:177], v[206:207] op_sel_hi:[1,0]
    v_pk_mul_f32 v[34:35], v[168:169], v[206:207] op_sel_hi:[1,0]
    v_pk_mul_f32 v[28:29], v[178:179], v[206:207] op_sel_hi:[1,0]
    v_pk_mul_f32 v[36:37], v[170:171], v[206:207] op_sel_hi:[1,0]
    v_pk_mul_f32 v[30:31], v[180:181], v[206:207] op_sel_hi:[1,0]
    v_pk_mul_f32 v[38:39], v[172:173], v[206:207] op_sel_hi:[1,0]
    v_pk_fma_f32 v[166:167], v[166:167], v[204:205], v[24:25] op_sel_hi:[1,0,1] neg_lo:[0,0,1] neg_hi:[0,0,1]
    v_pk_fma_f32 v[174:175], v[174:175], v[204:205], v[32:33] op_sel_hi:[1,0,1]
    v_pk_fma_f32 v[168:169], v[168:169], v[204:205], v[26:27] op_sel_hi:[1,0,1] neg_lo:[0,0,1] neg_hi:[0,0,1]
    v_pk_fma_f32 v[176:177], v[176:177], v[204:205], v[34:35] op_sel_hi:[1,0,1]
    v_pk_fma_f32 v[170:171], v[170:171], v[204:205], v[28:29] op_sel_hi:[1,0,1] neg_lo:[0,0,1] neg_hi:[0,0,1]
    v_pk_fma_f32 v[178:179], v[178:179], v[204:205], v[36:37] op_sel_hi:[1,0,1]
    v_pk_fma_f32 v[172:173], v[172:173], v[204:205], v[30:31] op_sel_hi:[1,0,1] neg_lo:[0,0,1] neg_hi:[0,0,1]
    v_pk_fma_f32 v[180:181], v[180:181], v[204:205], v[38:39] op_sel_hi:[1,0,1]
    v_cvt_pk_bf16_f32 v108, v166, v167
    v_cvt_pk_bf16_f32 v109, v168, v169
    v_cvt_pk_bf16_f32 v110, v170, v171
    v_cvt_pk_bf16_f32 v111, v172, v173
    v_cvt_pk_bf16_f32 v112, v174, v175
    v_cvt_pk_bf16_f32 v113, v176, v177
    v_cvt_pk_bf16_f32 v114, v178, v179
    v_cvt_pk_bf16_f32 v115, v180, v181
    v_pk_mul_f32 v[24:25], v[190:191], v[210:211] op_sel_hi:[1,0]
    v_pk_mul_f32 v[32:33], v[182:183], v[210:211] op_sel_hi:[1,0]
    v_pk_mul_f32 v[26:27], v[192:193], v[210:211] op_sel_hi:[1,0]
    v_pk_mul_f32 v[34:35], v[184:185], v[210:211] op_sel_hi:[1,0]
    v_pk_mul_f32 v[28:29], v[194:195], v[210:211] op_sel_hi:[1,0]
    v_pk_mul_f32 v[36:37], v[186:187], v[210:211] op_sel_hi:[1,0]
    v_pk_mul_f32 v[30:31], v[196:197], v[210:211] op_sel_hi:[1,0]
    v_pk_mul_f32 v[38:39], v[188:189], v[210:211] op_sel_hi:[1,0]
    v_pk_fma_f32 v[182:183], v[182:183], v[208:209], v[24:25] op_sel_hi:[1,0,1] neg_lo:[0,0,1] neg_hi:[0,0,1]
    v_pk_fma_f32 v[190:191], v[190:191], v[208:209], v[32:33] op_sel_hi:[1,0,1]
    v_pk_fma_f32 v[184:185], v[184:185], v[208:209], v[26:27] op_sel_hi:[1,0,1] neg_lo:[0,0,1] neg_hi:[0,0,1]
    v_pk_fma_f32 v[192:193], v[192:193], v[208:209], v[34:35] op_sel_hi:[1,0,1]
    v_pk_fma_f32 v[186:187], v[186:187], v[208:209], v[28:29] op_sel_hi:[1,0,1] neg_lo:[0,0,1] neg_hi:[0,0,1]
    v_pk_fma_f32 v[194:195], v[194:195], v[208:209], v[36:37] op_sel_hi:[1,0,1]
    v_pk_fma_f32 v[188:189], v[188:189], v[208:209], v[30:31] op_sel_hi:[1,0,1] neg_lo:[0,0,1] neg_hi:[0,0,1]
    v_pk_fma_f32 v[196:197], v[196:197], v[208:209], v[38:39] op_sel_hi:[1,0,1]
    v_cvt_pk_bf16_f32 v116, v182, v183
    v_cvt_pk_bf16_f32 v117, v184, v185
    v_cvt_pk_bf16_f32 v118, v186, v187
    v_cvt_pk_bf16_f32 v119, v188, v189
    v_cvt_pk_bf16_f32 v120, v190, v191
    v_cvt_pk_bf16_f32 v121, v192, v193
    v_cvt_pk_bf16_f32 v122, v194, v195
    v_cvt_pk_bf16_f32 v123, v196, v197
    s_mov_b64 exec, s[62:63]
    v_pk_mov_b32 v[104:105], v[22:23], v[22:23]
    v_pk_mov_b32 v[106:107], v[22:23], v[22:23]
    s_mov_b64 exec, -1
    s_add_u32 m0, s61, 106496
    s_add_u32 s58, s60, 128
    buffer_load_dwordx4 v8, s[28:31], s58 offen offset:0 lds
    buffer_load_dwordx4 v9, s[28:31], s58 offen offset:1024 lds
    buffer_load_dwordx4 v10, s[28:31], s58 offen offset:2048 lds
    buffer_load_dwordx4 v11, s[28:31], s58 offen offset:3072 lds
    s_add_u32 m0, s61, 122880
    s_add_u32 s58, s60, 768
    buffer_load_dwordx4 v8, s[28:31], s58 offen offset:0 lds
    buffer_load_dwordx4 v9, s[28:31], s58 offen offset:1024 lds
    buffer_load_dwordx4 v10, s[28:31], s58 offen offset:2048 lds
    buffer_load_dwordx4 v11, s[28:31], s58 offen offset:3072 lds
    s_waitcnt vmcnt(8)
    s_barrier
    s_add_u32 m0, s61, 0
    s_add_u32 s58, s60, 256
    buffer_load_dwordx4 v8, s[28:31], s58 offen offset:0 lds
    buffer_load_dwordx4 v9, s[28:31], s58 offen offset:1024 lds
    buffer_load_dwordx4 v10, s[28:31], s58 offen offset:2048 lds
    buffer_load_dwordx4 v11, s[28:31], s58 offen offset:3072 lds
    s_add_u32 m0, s61, 16384
    s_add_u32 s58, s60, 896
    buffer_load_dwordx4 v8, s[28:31], s58 offen offset:0 lds
    buffer_load_dwordx4 v9, s[28:31], s58 offen offset:1024 lds
    buffer_load_dwordx4 v10, s[28:31], s58 offen offset:2048 lds
    buffer_load_dwordx4 v11, s[28:31], s58 offen offset:3072 lds
    s_waitcnt vmcnt(8)
    s_barrier
    s_add_u32 m0, s61, 53248
    s_add_u32 s58, s60, 384
    buffer_load_dwordx4 v8, s[28:31], s58 offen offset:0 lds
    buffer_load_dwordx4 v9, s[28:31], s58 offen offset:1024 lds
    buffer_load_dwordx4 v10, s[28:31], s58 offen offset:2048 lds
    buffer_load_dwordx4 v11, s[28:31], s58 offen offset:3072 lds
    s_add_u32 m0, s61, 69632
    s_add_u32 s58, s60, 1024
    buffer_load_dwordx4 v8, s[28:31], s58 offen offset:0 lds
    buffer_load_dwordx4 v9, s[28:31], s58 offen offset:1024 lds
    buffer_load_dwordx4 v10, s[28:31], s58 offen offset:2048 lds
    buffer_load_dwordx4 v11, s[28:31], s58 offen offset:3072 lds
    ds_write_b128 v19, v[124:127] offset:0
    ds_write_b128 v19, v[128:131] offset:10240
    ds_write_b128 v19, v[132:135] offset:1024
    ds_write_b128 v19, v[136:139] offset:11264
    s_mov_b32 exec_hi, 0
    ds_write_b128 v19, v[140:143] offset:2048
    ds_write_b128 v19, v[144:147] offset:12288
    s_mov_b32 exec_hi, -1
    s_waitcnt vmcnt(8)
    s_barrier
    s_add_u32 m0, s61, 106496
    s_add_u32 s58, s60, 512
    buffer_load_dwordx4 v8, s[28:31], s58 offen offset:0 lds
    buffer_load_dwordx4 v9, s[28:31], s58 offen offset:1024 lds
    buffer_load_dwordx4 v10, s[28:31], s58 offen offset:2048 lds
    buffer_load_dwordx4 v11, s[28:31], s58 offen offset:3072 lds
    s_add_u32 m0, s61, 122880
    s_add_u32 s58, s60, 1152
    buffer_load_dwordx4 v8, s[28:31], s58 offen offset:0 lds
    buffer_load_dwordx4 v9, s[28:31], s58 offen offset:1024 lds
    buffer_load_dwordx4 v10, s[28:31], s58 offen offset:2048 lds
    buffer_load_dwordx4 v11, s[28:31], s58 offen offset:3072 lds
    ds_write_b128 v20, v[100:103] offset:0
    ds_write_b128 v20, v[104:107] offset:10240
    ds_write_b128 v20, v[108:111] offset:1024
    ds_write_b128 v20, v[112:115] offset:11264
    s_mov_b32 exec_hi, 0
    ds_write_b128 v20, v[116:119] offset:2048
    ds_write_b128 v20, v[120:123] offset:12288
    s_mov_b32 exec_hi, -1
    s_waitcnt vmcnt(8) lgkmcnt(0)
    s_barrier
    s_mov_b32 s36, s26
    s_mov_b32 s37, s27
    s_mov_b32 s38, 5505024
    s_mov_b32 s39, 0x20000
    s_mov_b32 s40, s18
    s_mov_b32 s41, s19
    s_mov_b32 s42, 819200
    s_mov_b32 s43, 0x20000
    s_mov_b32 s44, s24
    s_mov_b32 s45, s25
    s_mov_b32 s46, 256
    s_mov_b32 s47, 0x20000
    s_lshl_b32 s59, s56, 2
    s_add_u32 s59, s59, s51
    s_mul_i32 s59, s59, 25600
    v_lshlrev_b32 v2, 7, v0
    s_mov_b32 exec_hi, 0x3ffff
    buffer_load_dword v99, v2, s[40:43], s59 offen
    s_add_u32 s59, s59, 6400
    buffer_load_dword v99, v2, s[40:43], s59 offen
    s_add_u32 s59, s59, 6400
    buffer_load_dword v99, v2, s[40:43], s59 offen
    s_add_u32 s59, s59, 6400
    buffer_load_dword v99, v2, s[40:43], s59 offen
    s_add_u32 s59, s59, 6400
    s_mov_b32 exec_hi, -1
    v_add_u32 v2, 0, v0
    v_mul_u32_u24 v3, 6554, v2
    v_lshrrev_b32 v3, 16, v3
    v_mul_u32_u24 v4, 10, v3
    v_sub_u32 v2, v2, v4
    v_and_b32 v4, 3, v3
    v_and_b32 v72, 4, v3
    v_mul_u32_u24 v72, 20, v72
    v_and_b32 v3, 24, v3
    v_lshrrev_b32 v3, 1, v3
    v_add3_u32 v4, v4, v3, v72
    v_mul_u32_u24 v4, 1280, v4
    v_lshl_add_u32 v72, v2, 4, v4
    v_add_u32 v2, 64, v0
    v_mul_u32_u24 v3, 6554, v2
    v_lshrrev_b32 v3, 16, v3
    v_mul_u32_u24 v4, 10, v3
    v_sub_u32 v2, v2, v4
    v_and_b32 v4, 3, v3
    v_and_b32 v73, 4, v3
    v_mul_u32_u24 v73, 20, v73
    v_and_b32 v3, 24, v3
    v_lshrrev_b32 v3, 1, v3
    v_add3_u32 v4, v4, v3, v73
    v_mul_u32_u24 v4, 1280, v4
    v_lshl_add_u32 v73, v2, 4, v4
    v_subrev_u32 v73, 1024, v73
    v_add_u32 v2, 128, v0
    v_mul_u32_u24 v3, 6554, v2
    v_lshrrev_b32 v3, 16, v3
    v_mul_u32_u24 v4, 10, v3
    v_sub_u32 v2, v2, v4
    v_and_b32 v4, 3, v3
    v_and_b32 v74, 4, v3
    v_mul_u32_u24 v74, 20, v74
    v_and_b32 v3, 24, v3
    v_lshrrev_b32 v3, 1, v3
    v_add3_u32 v4, v4, v3, v74
    v_mul_u32_u24 v4, 1280, v4
    v_lshl_add_u32 v74, v2, 4, v4
    v_subrev_u32 v74, 2048, v74
    v_add_u32 v2, 192, v0
    v_mul_u32_u24 v3, 6554, v2
    v_lshrrev_b32 v3, 16, v3
    v_mul_u32_u24 v4, 10, v3
    v_sub_u32 v2, v2, v4
    v_and_b32 v4, 3, v3
    v_and_b32 v75, 4, v3
    v_mul_u32_u24 v75, 20, v75
    v_and_b32 v3, 24, v3
    v_lshrrev_b32 v3, 1, v3
    v_add3_u32 v4, v4, v3, v75
    v_mul_u32_u24 v4, 1280, v4
    v_lshl_add_u32 v75, v2, 4, v4
    v_subrev_u32 v75, 3072, v75
    v_add_u32 v2, 256, v0
    v_mul_u32_u24 v3, 6554, v2
    v_lshrrev_b32 v3, 16, v3
    v_mul_u32_u24 v4, 10, v3
    v_sub_u32 v2, v2, v4
    v_and_b32 v4, 3, v3
    v_and_b32 v76, 4, v3
    v_mul_u32_u24 v76, 20, v76
    v_and_b32 v3, 24, v3
    v_lshrrev_b32 v3, 1, v3
    v_add3_u32 v4, v4, v3, v76
    v_mul_u32_u24 v4, 1280, v4
    v_lshl_add_u32 v76, v2, 4, v4
    s_waitcnt vmcnt(4)
    s_barrier
    s_load_dwordx8 s[76:83], s[24:25], 0
    s_barrier
    s_waitcnt lgkmcnt(0)
    s_and_b64 s[76:77], s[76:77], s[78:79]
    s_and_b64 s[80:81], s[80:81], s[82:83]
    s_and_b64 s[76:77], s[76:77], s[80:81]
    s_and_b32 s76, s76, s77
    s_cbranch_scc1 L_COK5
    s_mov_b32 s71, 0
    v_lshlrev_b32 v100, 2, v0
    s_mov_b64 exec, 0xff
L_CLP6:
    s_sleep 16
    buffer_load_dword v101, v100, s[44:47], 0 offen sc1
    s_waitcnt vmcnt(0)
    v_cmp_eq_u32 vcc, 0, v101
    s_cbranch_vccz L_CLP6x
    s_add_u32 s71, s71, 1
    s_cmp_gt_u32 s71, 200000
    s_cbranch_scc0 L_CLP6
L_CLP6x:
    s_mov_b64 exec, -1
L_COK5:
    s_barrier
    s_mul_i32 s70, s52, 40
    s_sub_u32 s71, 320, s70
    s_cmp_lt_u32 s52, 4
    s_cselect_b32 s70, s70, s71
    s_cselect_b32 s71, 16, -16
    s_cselect_b32 s73, 0, -16
    s_mul_i32 s72, s54, 5376
    s_add_u32 s70, s70, s72
    s_lshl_b32 s70, s70, 4
    s_add_u32 s70, s70, 2621440
    v_add_u32 v100, 0, v0
    v_mul_u32_u24 v101, 1639, v100
    v_lshrrev_b32 v101, 16, v101
    v_mul_u32_u24 v102, 40, v101
    v_sub_u32 v100, v100, v102
    v_mul_i32_i24 v100, s71, v100
    v_and_b32 v102, 1, v101
    v_mul_i32_i24 v102, s73, v102
    v_mul_u32_u24 v101, 2688, v101
    v_add3_u32 v100, v100, v101, v102
    v_add_u32 v77, s70, v100
    v_add_u32 v100, 64, v0
    v_mul_u32_u24 v101, 1639, v100
    v_lshrrev_b32 v101, 16, v101
    v_mul_u32_u24 v102, 40, v101
    v_sub_u32 v100, v100, v102
    v_mul_i32_i24 v100, s71, v100
    v_and_b32 v102, 1, v101
    v_mul_i32_i24 v102, s73, v102
    v_mul_u32_u24 v101, 2688, v101
    v_add3_u32 v100, v100, v101, v102
    v_add_u32 v78, s70, v100
    v_subrev_u32 v78, 1024, v78
    v_add_u32 v100, 128, v0
    v_mul_u32_u24 v101, 1639, v100
    v_lshrrev_b32 v101, 16, v101
    v_mul_u32_u24 v102, 40, v101
    v_sub_u32 v100, v100, v102
    v_mul_i32_i24 v100, s71, v100
    v_and_b32 v102, 1, v101
    v_mul_i32_i24 v102, s73, v102
    v_mul_u32_u24 v101, 2688, v101
    v_add3_u32 v100, v100, v101, v102
    v_add_u32 v79, s70, v100
    v_subrev_u32 v79, 2048, v79
    v_add_u32 v100, 192, v0
    v_mul_u32_u24 v101, 1639, v100
    v_lshrrev_b32 v101, 16, v101
    v_mul_u32_u24 v102, 40, v101
    v_sub_u32 v100, v100, v102
    v_mul_i32_i24 v100, s71, v100
    v_and_b32 v102, 1, v101
    v_mul_i32_i24 v102, s73, v102
    v_mul_u32_u24 v101, 2688, v101
    v_add3_u32 v100, v100, v101, v102
    v_add_u32 v80, s70, v100
    v_subrev_u32 v80, 3072, v80
    v_add_u32 v100, 256, v0
    v_mul_u32_u24 v101, 1639, v100
    v_lshrrev_b32 v101, 16, v101
    v_mul_u32_u24 v102, 40, v101
    v_sub_u32 v100, v100, v102
    v_mul_i32_i24 v100, s71, v100
    v_and_b32 v102, 1, v101
    v_mul_i32_i24 v102, s73, v102
    v_mul_u32_u24 v101, 2688, v101
    v_add3_u32 v100, v100, v101, v102
    v_add_u32 v81, s70, v100
    s_lshr_b32 s56, s3, 2
    v_and_b32 v2, 15, v0
    v_lshrrev_b32 v3, 4, v0
    v_bfe_u32 v4, v0, 2, 3
    v_lshrrev_b32 v5, 5, v0
    v_lshl_add_u32 v4, v5, 4, v4
    v_mul_u32_u24 v4, 160, v4
    v_and_b32 v5, 3, v0
    v_lshl_add_u32 v4, v5, 3, v4
    s_mul_i32 s58, s56, 35840
    v_add_u32 v8, s58, v4
    s_mul_i32 s58, s56, 15360
    s_add_u32 s58, s58, 71680
    v_add_u32 v9, s58, v4
    s_mul_i32 s57, s53, 1280
    s_mul_i32 s58, s52, 160
    s_add_u32 s57, s57, s58
    s_lshl_b32 s58, s3, 6
    s_add_u32 s58, s58, 0
    s_mov_b32 s59, 133120
    v_add_u32 v4, s58, v0
    v_mul_u32_u24 v5, 6554, v4
    v_lshrrev_b32 v5, 16, v5
    v_lshl_add_u32 v249, v5, 2, s59
    v_mul_u32_u24 v6, 10, v5
    v_sub_u32 v4, v4, v6
    v_mul_u32_u24 v6, 40960, v5
    v_lshl_add_u32 v6, v4, 4, v6
    v_add_u32 v26, s57, v6
    v_mul_u32_u24 v6, 336, v5
    v_lshl_add_u32 v4, v4, 5, v6
    v_lshrrev_b32 v5, 4, v5
    v_mul_u32_u24 v6, 4864, v5
    v_add_u32 v252, v4, v6
    v_add_u32 v5, 1, v5
    v_lshrrev_b32 v5, 2, v5
    v_mul_u32_u24 v5, 30720, v5
    v_add_u32 v253, v252, v5
    s_mul_i32 s57, s53, 1280
    s_mul_i32 s58, s52, 160
    s_add_u32 s57, s57, s58
    s_lshl_b32 s58, s3, 6
    s_add_u32 s58, s58, 512
    s_mov_b32 s59, 133120
    v_add_u32 v4, s58, v0
    v_mul_u32_u24 v5, 6554, v4
    v_lshrrev_b32 v5, 16, v5
    v_lshl_add_u32 v251, v5, 2, s59
    v_mul_u32_u24 v6, 10, v5
    v_sub_u32 v4, v4, v6
    v_mul_u32_u24 v6, 40960, v5
    v_lshl_add_u32 v6, v4, 4, v6
    v_add_u32 v27, s57, v6
    v_mul_u32_u24 v6, 336, v5
    v_lshl_add_u32 v4, v4, 5, v6
    v_lshrrev_b32 v5, 4, v5
    v_mul_u32_u24 v6, 4864, v5
    v_add_u32 v254, v4, v6
    v_add_u32 v5, 1, v5
    v_lshrrev_b32 v5, 2, v5
    v_mul_u32_u24 v5, 30720, v5
    v_add_u32 v255, v254, v5
    s_lshl_b32 s57, s56, 1
    s_add_u32 s57, s57, s52
    s_add_u32 s57, s57, 0
    s_and_b32 s57, s57, 3
    s_lshl_b32 s58, s53, 2
    s_add_u32 s57, s57, s58
    s_lshl_b32 s57, s57, 3
    s_add_u32 s57, s57, s51
    s_mul_i32 s62, s57, 2560
    s_lshl_b32 s57, s56, 1
    s_add_u32 s57, s57, s52
    s_add_u32 s57, s57, 1
    s_and_b32 s57, s57, 3
    s_lshl_b32 s58, s53, 2
    s_add_u32 s57, s57, s58
    s_lshl_b32 s57, s57, 3
    s_add_u32 s57, s57, s51
    s_mul_i32 s63, s57, 2560
    s_mul_i32 s61, s3, 10240
    s_cmp_eq_u32 s3, 7
    s_cselect_b32 s61, 102400, s61
    v_and_b32 v4, 1, v3
    v_lshrrev_b32 v5, 1, v3
    v_xor_b32 v5, v5, v4
    v_mul_u32_u24 v4, 2560, v4
    v_lshl_add_u32 v4, v5, 4, v4
    v_mul_u32_u24 v5, 160, v2
    v_add3_u32 v20, v4, v5, s61
    v_mul_u32_u24 v22, 336, v2
    v_lshl_add_u32 v22, v3, 4, v22
    v_add_u32 v22, s61, v22
    v_lshlrev_b32 v10, 4, v0
    v_mov_b32 v11, v10
    v_xor_b32 v4, 16, v10
    v_add_u32 v13, 7680, v4
    v_add_u32 v14, 11776, v4
    v_add_u32 v12, 7680, v4
    s_mov_b32 exec_hi, 0
    v_mov_b32 v12, v10
    s_mov_b32 exec_hi, -1
    s_and_b32 s65, s2, 7
    s_lshl_b32 s65, s65, 13
    s_add_u32 s65, s65, 5439488
    s_and_b32 s70, s50, 3
    s_mul_i32 s70, s70, 640
    s_add_u32 s60, s65, s70
    s_and_b32 s70, s50, 4
    s_lshl_b32 s70, s70, 10
    s_add_u32 s60, s60, s70
    v_lshlrev_b32 v21, 7, v0
    v_and_b32 v4, 1, v2
    v_mul_u32_u24 v4, 640, v4
    v_lshrrev_b32 v5, 1, v2
    v_lshl_add_u32 v4, v5, 4, v4
    v_mul_u32_u24 v5, 5120, v3
    s_mov_b32 s57, 112640
    v_add3_u32 v23, v4, v5, s57
    s_lshl_b32 s57, s51, 6
    s_add_u32 s57, s57, 133120
    v_lshlrev_b32 v7, 2, v2
    v_add_u32 v7, s57, v7
    s_mul_i32 s71, s50, 52
    s_lshr_b32 s71, s71, 8
    s_mul_i32 s70, s71, 5
    s_sub_u32 s70, s50, s70
    s_lshl_b32 s71, s71, 2
    s_add_u32 s71, s71, s49
    s_lshl_b32 s71, 1, s71
    s_and_b32 s71, s71, 65535
    v_mov_b32 v4, s71
    v_cmp_eq_u32 vcc, s70, v0
    s_nop 1
    v_cndmask_b32_e64 v192, 0, v4, vcc
    v_mov_b32 v196, v77
    v_mov_b32 v197, v78
    v_mov_b32 v198, v79
    v_mov_b32 v199, v80
    v_mov_b32 v200, v81
    s_barrier
    s_cmp_lg_u32 s3, 4
    s_cbranch_scc1 L_NOPUB
    s_lshl_b32 s70, s48, 5
    s_add_u32 s70, s70, s50
    s_lshl_b32 s70, s70, 7
    s_add_u32 s70, s70, 5439488
    s_lshl_b32 s71, 1, s49
    v_lshlrev_b32 v100, 13, v0
    v_mov_b32 v101, s71
    s_mov_b32 exec_lo, 0xff
    s_mov_b32 exec_hi, 0
    buffer_atomic_or v101, v100, s[36:39], s70 offen sc1
    s_mov_b64 exec, -1
L_NOPUB:
    s_lshl_b32 s70, s51, 3
    s_lshr_b32 s70, 0x3020100, s70
    s_and_b32 s71, s70, 15
    s_mul_i32 s71, s71, 20480
    s_lshr_b32 s70, s70, 4
    s_add_u32 s70, s70, s52
    s_and_b32 s70, s70, 3
    s_mul_i32 s70, s70, 204800
    s_add_u32 s71, s71, s70
    s_mul_i32 s70, s52, 160
    s_add_u32 s71, s71, s70
    s_mul_i32 s70, s51, 5120
    s_add_u32 m0, s70, 0
    s_nop 0
    buffer_load_dwordx4 v72, s[40:43], s71 offen offset:0 lds
    buffer_load_dwordx4 v73, s[40:43], s71 offen offset:1024 lds
    buffer_load_dwordx4 v74, s[40:43], s71 offen offset:2048 lds
    buffer_load_dwordx4 v75, s[40:43], s71 offen offset:3072 lds
    s_add_u32 m0, m0, 4096
    s_nop 0
    buffer_load_dwordx4 v76, s[40:43], s71 offen offset:0 lds
    s_lshl_b32 s70, s51, 3
    s_lshr_b32 s70, 0x20111004, s70
    s_and_b32 s71, s70, 15
    s_mul_i32 s71, s71, 20480
    s_lshr_b32 s70, s70, 4
    s_add_u32 s70, s70, s52
    s_and_b32 s70, s70, 3
    s_mul_i32 s70, s70, 204800
    s_add_u32 s71, s71, s70
    s_mul_i32 s70, s52, 160
    s_add_u32 s71, s71, s70
    s_mul_i32 s70, s51, 5120
    s_add_u32 m0, s70, 20480
    s_nop 0
    buffer_load_dwordx4 v72, s[40:43], s71 offen offset:0 lds
    buffer_load_dwordx4 v73, s[40:43], s71 offen offset:1024 lds
    buffer_load_dwordx4 v74, s[40:43], s71 offen offset:2048 lds
    buffer_load_dwordx4 v75, s[40:43], s71 offen offset:3072 lds
    s_add_u32 m0, m0, 4096
    s_nop 0
    buffer_load_dwordx4 v76, s[40:43], s71 offen offset:0 lds
    s_lshl_b32 s70, s51, 3
    s_lshr_b32 s70, 0x24232221, s70
    s_and_b32 s71, s70, 15
    s_mul_i32 s71, s71, 20480
    s_lshr_b32 s70, s70, 4
    s_add_u32 s70, s70, s52
    s_and_b32 s70, s70, 3
    s_mul_i32 s70, s70, 204800
    s_add_u32 s71, s71, s70
    s_mul_i32 s70, s52, 160
    s_add_u32 s71, s71, s70
    s_mul_i32 s70, s51, 5120
    s_add_u32 m0, s70, 40960
    s_nop 0
    buffer_load_dwordx4 v72, s[40:43], s71 offen offset:0 lds
    buffer_load_dwordx4 v73, s[40:43], s71 offen offset:1024 lds
    buffer_load_dwordx4 v74, s[40:43], s71 offen offset:2048 lds
    buffer_load_dwordx4 v75, s[40:43], s71 offen offset:3072 lds
    s_add_u32 m0, m0, 4096
    s_nop 0
    buffer_load_dwordx4 v76, s[40:43], s71 offen offset:0 lds
    s_lshl_b32 s70, s51, 3
    s_lshr_b32 s70, 0x13123130, s70
    s_and_b32 s71, s70, 15
    s_mul_i32 s71, s71, 20480
    s_lshr_b32 s70, s70, 4
    s_add_u32 s70, s70, s52
    s_and_b32 s70, s70, 3
    s_mul_i32 s70, s70, 204800
    s_add_u32 s71, s71, s70
    s_mul_i32 s70, s52, 160
    s_add_u32 s71, s71, s70
    s_mul_i32 s70, s51, 5120
    s_add_u32 m0, s70, 61440
    s_nop 0
    buffer_load_dwordx4 v72, s[40:43], s71 offen offset:0 lds
    buffer_load_dwordx4 v73, s[40:43], s71 offen offset:1024 lds
    buffer_load_dwordx4 v74, s[40:43], s71 offen offset:2048 lds
    buffer_load_dwordx4 v75, s[40:43], s71 offen offset:3072 lds
    s_add_u32 m0, m0, 4096
    s_nop 0
    buffer_load_dwordx4 v76, s[40:43], s71 offen offset:0 lds
    s_lshl_b32 s70, s51, 3
    s_lshr_b32 s70, 0x34333214, s70
    s_and_b32 s71, s70, 15
    s_mul_i32 s71, s71, 20480
    s_lshr_b32 s70, s70, 4
    s_add_u32 s70, s70, s52
    s_and_b32 s70, s70, 3
    s_mul_i32 s70, s70, 204800
    s_add_u32 s71, s71, s70
    s_mul_i32 s70, s52, 160
    s_add_u32 s71, s71, s70
    s_mul_i32 s70, s51, 5120
    s_add_u32 m0, s70, 81920
    s_nop 0
    buffer_load_dwordx4 v72, s[40:43], s71 offen offset:0 lds
    buffer_load_dwordx4 v73, s[40:43], s71 offen offset:1024 lds
    buffer_load_dwordx4 v74, s[40:43], s71 offen offset:2048 lds
    buffer_load_dwordx4 v75, s[40:43], s71 offen offset:3072 lds
    s_add_u32 m0, m0, 4096
    s_nop 0
    buffer_load_dwordx4 v76, s[40:43], s71 offen offset:0 lds
    s_branch L_P2H2
L_DCOMP:
    s_sub_u32 s56, s50, 24
    s_lshl_b32 s57, s56, 3
    s_lshl_b32 s70, s51, 1
    s_add_u32 s57, s57, s70
    s_add_u32 s57, s57, s48
    v_and_b32 v2, 15, v0
    v_lshrrev_b32 v3, 4, v0
    v_lshrrev_b32 v4, 1, v2
    s_lshl_b32 s59, s51, 3
    v_add_u32 v4, s59, v4
    v_cvt_f32_u32 v4, v4
    v_mul_f32 v4, 0xbd000000, v4
    v_lshlrev_b32 v5, 2, v3
    v_cvt_f32_u32 v5, v5
    v_mul_f32 v5, v5, v4
    v_fmamk_f32 v208, v4, 0x0, v5
    v_fmamk_f32 v209, v4, 0x3f800000, v5
    v_fmamk_f32 v210, v4, 0x40000000, v5
    v_fmamk_f32 v211, v4, 0x40400000, v5
    v_fmamk_f32 v212, v4, 0x41800000, v5
    v_fmamk_f32 v213, v4, 0x41880000, v5
    v_fmamk_f32 v214, v4, 0x41900000, v5
    v_fmamk_f32 v215, v4, 0x41980000, v5
    v_cos_f32 v216, v208
    v_sin_f32 v208, v208
    v_cos_f32 v217, v209
    v_sin_f32 v209, v209
    v_cos_f32 v218, v210
    v_sin_f32 v210, v210
    v_cos_f32 v219, v211
    v_sin_f32 v211, v211
    v_cos_f32 v220, v212
    v_sin_f32 v212, v212
    v_cos_f32 v221, v213
    v_sin_f32 v213, v213
    v_cos_f32 v222, v214
    v_sin_f32 v214, v214
    v_cos_f32 v223, v215
    v_sin_f32 v215, v215
    v_cvt_pk_bf16_f32 v200, v216, v217
    v_cvt_pk_bf16_f32 v204, v208, v209
    v_cvt_pk_bf16_f32 v201, v218, v219
    v_cvt_pk_bf16_f32 v205, v210, v211
    v_cvt_pk_bf16_f32 v202, v220, v221
    v_cvt_pk_bf16_f32 v206, v212, v213
    v_cvt_pk_bf16_f32 v203, v222, v223
    v_cvt_pk_bf16_f32 v207, v214, v215
    s_waitcnt lgkmcnt(0)
    s_mov_b32 s36, s26
    s_mov_b32 s37, s27
    s_mov_b32 s38, 5505024
    s_mov_b32 s39, 0x20000
    s_cmp_lg_u32 s49, 0
    s_cbranch_scc1 L_NOG3
    s_lshl_b32 s70, s51, 7
    s_lshl_b32 s71, s56, 1
    s_add_u32 s70, s70, s71
    s_add_u32 s70, s70, s48
    s_mul_i32 s70, s70, 5376
    s_add_u32 s70, s70, 2624000
    v_and_b32 v4, 7, v0
    v_mul_u32_u24 v4, 86016, v4
    buffer_load_dword v187, v4, s[36:39], s70 offen sc1
L_NOG3:
    v_pk_mov_b32 v[24:25], 0, 0
    v_pk_mov_b32 v[26:27], 0, 0
    v_pk_mov_b32 v[28:29], 0, 0
    v_pk_mov_b32 v[30:31], 0, 0
    v_pk_mov_b32 v[32:33], 0, 0
    v_pk_mov_b32 v[34:35], 0, 0
    v_pk_mov_b32 v[36:37], 0, 0
    v_pk_mov_b32 v[38:39], 0, 0
    v_pk_mov_b32 v[40:41], 0, 0
    v_pk_mov_b32 v[42:43], 0, 0
    v_pk_mov_b32 v[44:45], 0, 0
    v_pk_mov_b32 v[46:47], 0, 0
    v_pk_mov_b32 v[48:49], 0, 0
    v_pk_mov_b32 v[50:51], 0, 0
    v_pk_mov_b32 v[52:53], 0, 0
    v_pk_mov_b32 v[54:55], 0, 0
    v_pk_mov_b32 v[56:57], 0, 0
    v_pk_mov_b32 v[58:59], 0, 0
    v_pk_mov_b32 v[60:61], 0, 0
    v_pk_mov_b32 v[62:63], 0, 0
    v_pk_mov_b32 v[64:65], 0, 0
    v_pk_mov_b32 v[66:67], 0, 0
    v_pk_mov_b32 v[68:69], 0, 0
    v_pk_mov_b32 v[70:71], 0, 0
    v_pk_mov_b32 v[72:73], 0, 0
    v_pk_mov_b32 v[74:75], 0, 0
    v_pk_mov_b32 v[76:77], 0, 0
    v_pk_mov_b32 v[78:79], 0, 0
    v_pk_mov_b32 v[80:81], 0, 0
    v_pk_mov_b32 v[82:83], 0, 0
    v_pk_mov_b32 v[84:85], 0, 0
    v_pk_mov_b32 v[86:87], 0, 0
    v_pk_mov_b32 v[88:89], 0, 0
    v_pk_mov_b32 v[90:91], 0, 0
    v_pk_mov_b32 v[92:93], 0, 0
    v_pk_mov_b32 v[94:95], 0, 0
    v_pk_mov_b32 v[96:97], 0, 0
    v_pk_mov_b32 v[98:99], 0, 0
    v_pk_mov_b32 v[100:101], 0, 0
    v_pk_mov_b32 v[102:103], 0, 0
    s_lshl_b32 s70, s3, 8
    s_add_u32 s70, s70, s50
    s_cmp_lg_u32 s70, 31
    s_cbranch_scc1 L_NOCLR
    v_lshlrev_b32 v4, 7, v0
    s_and_b32 s70, s2, 7
    s_lshl_b32 s70, s70, 13
    s_add_u32 s70, s70, 5439488
    buffer_store_dwordx4 v[24:27], v4, s[36:39], s70 offen sc1
L_NOCLR:
    v_bfe_u32 v4, v2, 1, 3
    v_xor_b32 v4, v4, v3
    v_lshlrev_b32 v4, 4, v4
    v_lshl_add_u32 v4, v2, 7, v4
    s_lshl_b32 s59, s51, 12
    s_add_u32 s59, s59, 53248
    v_add_u32 v7, s59, v4
    v_xor_b32 v8, 64, v7
    v_add_u32 v9, 86016, v4
    v_xor_b32 v10, 64, v9
    s_cmp_eq_u32 s49, 0
    s_cselect_b32 s66, 0x00010001, 0
    s_mov_b32 s67, s66
    v_lshlrev_b32 v4, 2, v3
    v_sub_u32 v4, v2, v4
    s_bitcmp1_b32 s49, 0
    s_cselect_b32 s70, 0x80008000, 0
    v_pk_mov_b32 v[12:13], 0, 0
    v_pk_mov_b32 v[16:17], 0, 0
    v_pk_mov_b32 v[20:21], 0, 0
    v_mov_b32 v5, 0x3f80
    v_cmp_eq_u32 vcc, 0, v4
    s_nop 1
    v_cndmask_b32_e64 v14, 0, v5, vcc
    v_mov_b32 v5, 0x3f800000
    v_cmp_eq_u32 vcc, 1, v4
    s_nop 1
    v_cndmask_b32_e64 v14, v14, v5, vcc
    v_xor_b32 v18, s70, v14
    v_mov_b32 v5, 0x3f80
    v_cmp_eq_u32 vcc, 2, v4
    s_nop 1
    v_cndmask_b32_e64 v15, 0, v5, vcc
    v_mov_b32 v5, 0x3f800000
    v_cmp_eq_u32 vcc, 3, v4
    s_nop 1
    v_cndmask_b32_e64 v15, v15, v5, vcc
    v_xor_b32 v19, s70, v15
    s_waitcnt vmcnt(0)
    s_mov_b32 s44, s24
    s_mov_b32 s45, s25
    s_mov_b32 s46, 256
    s_mov_b32 s47, 0x20000
    s_lshl_b32 s70, s3, 8
    s_add_u32 s70, s70, s50
    s_cmp_lg_u32 s70, 31
    s_cbranch_scc1 L_NOCLR2
    s_and_b32 s70, s2, 7
    s_lshl_b32 s70, s70, 2
    v_mov_b32 v4, 1
    s_mov_b64 exec, 1
    buffer_store_dword v4, v24, s[44:47], s70 offen sc1
    s_mov_b64 exec, -1
L_NOCLR2:
    s_barrier
    ds_read_b128 v[184:187], v7 offset:0
    ds_read_b128 v[188:191], v7 offset:16384
    ds_read_b128 v[192:195], v7 offset:2048
    ds_read_b128 v[196:199], v7 offset:18432
    ds_read_b128 v[104:107], v9 offset:0
    ds_read_b128 v[108:111], v9 offset:2048
    ds_read_b128 v[112:115], v9 offset:4096
    ds_read_b128 v[116:119], v9 offset:6144
    ds_read_b128 v[120:123], v9 offset:8192
    ds_read_b128 v[124:127], v9 offset:10240
    ds_read_b128 v[128:131], v9 offset:12288
    ds_read_b128 v[132:135], v9 offset:14336
    ds_read_b128 v[136:139], v9 offset:16384
    ds_read_b128 v[140:143], v9 offset:18432
    s_waitcnt lgkmcnt(10)
    v_mfma_f32_16x16x32_bf16 v[208:211], v[14:17], v[184:187], 0
    v_mfma_f32_16x16x32_bf16 v[212:215], v[12:15], v[184:187], 0
    v_mfma_f32_16x16x32_bf16 v[216:219], v[14:17], v[192:195], 0
    v_mfma_f32_16x16x32_bf16 v[220:223], v[12:15], v[192:195], 0
    v_mfma_f32_16x16x32_bf16 v[208:211], v[18:21], v[188:191], v[208:211]
    v_mfma_f32_16x16x32_bf16 v[212:215], v[16:19], v[188:191], v[212:215]
    v_mfma_f32_16x16x32_bf16 v[216:219], v[18:21], v[196:199], v[216:219]
    v_mfma_f32_16x16x32_bf16 v[220:223], v[16:19], v[196:199], v[220:223]
    s_nop 4
    v_cvt_pk_bf16_f32 v224, v208, v209
    v_cvt_pk_bf16_f32 v225, v210, v211
    v_cvt_pk_bf16_f32 v226, v212, v213
    v_cvt_pk_bf16_f32 v227, v214, v215
    v_cvt_pk_bf16_f32 v228, v216, v217
    v_cvt_pk_bf16_f32 v229, v218, v219
    v_cvt_pk_bf16_f32 v230, v220, v221
    v_cvt_pk_bf16_f32 v231, v222, v223
    s_waitcnt lgkmcnt(0)
    v_mfma_f32_16x16x32_bf16 v[24:27], v[224:227], v[104:107], v[24:27]
    ds_read_b128 v[184:187], v8 offset:0
    v_mfma_f32_16x16x32_bf16 v[28:31], v[228:231], v[104:107], v[28:31]
    ds_read_b128 v[188:191], v8 offset:16384
    v_mfma_f32_16x16x32_bf16 v[32:35], v[224:227], v[108:111], v[32:35]
    ds_read_b128 v[192:195], v8 offset:2048
    v_mfma_f32_16x16x32_bf16 v[36:39], v[228:231], v[108:111], v[36:39]
    ds_read_b128 v[196:199], v8 offset:18432
    v_mfma_f32_16x16x32_bf16 v[40:43], v[224:227], v[112:115], v[40:43]
    ds_read_b128 v[144:147], v10 offset:0
    v_mfma_f32_16x16x32_bf16 v[44:47], v[228:231], v[112:115], v[44:47]
    ds_read_b128 v[148:151], v10 offset:2048
    v_mfma_f32_16x16x32_bf16 v[48:51], v[224:227], v[116:119], v[48:51]
    ds_read_b128 v[152:155], v10 offset:4096
    v_mfma_f32_16x16x32_bf16 v[52:55], v[228:231], v[116:119], v[52:55]
    ds_read_b128 v[156:159], v10 offset:6144
    v_mfma_f32_16x16x32_bf16 v[56:59], v[224:227], v[120:123], v[56:59]
    ds_read_b128 v[160:163], v10 offset:8192
    s_waitcnt lgkmcnt(5)
    v_mfma_f32_16x16x32_bf16 v[208:211], v[14:17], v[184:187], 0
    ds_read_b128 v[164:167], v10 offset:10240
    v_mfma_f32_16x16x32_bf16 v[212:215], v[12:15], v[184:187], 0
    ds_read_b128 v[168:171], v10 offset:12288
    v_mfma_f32_16x16x32_bf16 v[216:219], v[14:17], v[192:195], 0
    ds_read_b128 v[172:175], v10 offset:14336
    v_mfma_f32_16x16x32_bf16 v[220:223], v[12:15], v[192:195], 0
    ds_read_b128 v[176:179], v10 offset:16384
    v_mfma_f32_16x16x32_bf16 v[208:211], v[18:21], v[188:191], v[208:211]
    ds_read_b128 v[180:183], v10 offset:18432
    v_mfma_f32_16x16x32_bf16 v[212:215], v[16:19], v[188:191], v[212:215]
    v_mfma_f32_16x16x32_bf16 v[216:219], v[18:21], v[196:199], v[216:219]
    v_mfma_f32_16x16x32_bf16 v[220:223], v[16:19], v[196:199], v[220:223]
    v_mfma_f32_16x16x32_bf16 v[60:63], v[228:231], v[120:123], v[60:63]
    v_mfma_f32_16x16x32_bf16 v[64:67], v[224:227], v[124:127], v[64:67]
    v_mfma_f32_16x16x32_bf16 v[68:71], v[228:231], v[124:127], v[68:71]
    v_mfma_f32_16x16x32_bf16 v[72:75], v[224:227], v[128:131], v[72:75]
    v_cvt_pk_bf16_f32 v232, v208, v209
    v_cvt_pk_bf16_f32 v233, v210, v211
    v_mfma_f32_16x16x32_bf16 v[76:79], v[228:231], v[128:131], v[76:79]
    v_cvt_pk_bf16_f32 v234, v212, v213
    v_cvt_pk_bf16_f32 v235, v214, v215
    v_mfma_f32_16x16x32_bf16 v[80:83], v[224:227], v[132:135], v[80:83]
    v_cvt_pk_bf16_f32 v236, v216, v217
    v_cvt_pk_bf16_f32 v237, v218, v219
    v_mfma_f32_16x16x32_bf16 v[84:87], v[228:231], v[132:135], v[84:87]
    v_cvt_pk_bf16_f32 v238, v220, v221
    v_cvt_pk_bf16_f32 v239, v222, v223
    v_mfma_f32_16x16x32_bf16 v[88:91], v[224:227], v[136:139], v[88:91]
    v_mfma_f32_16x16x32_bf16 v[92:95], v[228:231], v[136:139], v[92:95]
    v_mfma_f32_16x16x32_bf16 v[96:99], v[224:227], v[140:143], v[96:99]
    v_mfma_f32_16x16x32_bf16 v[100:103], v[228:231], v[140:143], v[100:103]
    s_waitcnt lgkmcnt(0)
    v_add_u32 v7, 53248, v7
    v_add_u32 v8, 53248, v8
    v_add_u32 v9, 53248, v9
    v_add_u32 v10, 53248, v10
    s_barrier
    v_mfma_f32_16x16x32_bf16 v[24:27], v[232:235], v[144:147], v[24:27]
    ds_read_b128 v[184:187], v7 offset:0
    v_mfma_f32_16x16x32_bf16 v[28:31], v[236:239], v[144:147], v[28:31]
    ds_read_b128 v[188:191], v7 offset:16384
    v_mfma_f32_16x16x32_bf16 v[32:35], v[232:235], v[148:151], v[32:35]
    ds_read_b128 v[192:195], v7 offset:2048
    v_mfma_f32_16x16x32_bf16 v[36:39], v[236:239], v[148:151], v[36:39]
    ds_read_b128 v[196:199], v7 offset:18432
    v_mfma_f32_16x16x32_bf16 v[40:43], v[232:235], v[152:155], v[40:43]
    ds_read_b128 v[104:107], v9 offset:0
    v_mfma_f32_16x16x32_bf16 v[44:47], v[236:239], v[152:155], v[44:47]
    ds_read_b128 v[108:111], v9 offset:2048
    v_mfma_f32_16x16x32_bf16 v[48:51], v[232:235], v[156:159], v[48:51]
    ds_read_b128 v[112:115], v9 offset:4096
    v_mfma_f32_16x16x32_bf16 v[52:55], v[236:239], v[156:159], v[52:55]
    ds_read_b128 v[116:119], v9 offset:6144
    v_mfma_f32_16x16x32_bf16 v[56:59], v[232:235], v[160:163], v[56:59]
    ds_read_b128 v[120:123], v9 offset:8192
    s_waitcnt lgkmcnt(5)
    v_mfma_f32_16x16x32_bf16 v[208:211], v[14:17], v[184:187], 0
    ds_read_b128 v[124:127], v9 offset:10240
    v_mfma_f32_16x16x32_bf16 v[212:215], v[12:15], v[184:187], 0
    ds_read_b128 v[128:131], v9 offset:12288
    v_mfma_f32_16x16x32_bf16 v[216:219], v[14:17], v[192:195], 0
    ds_read_b128 v[132:135], v9 offset:14336
    v_mfma_f32_16x16x32_bf16 v[220:223], v[12:15], v[192:195], 0
    ds_read_b128 v[136:139], v9 offset:16384
    v_mfma_f32_16x16x32_bf16 v[208:211], v[18:21], v[188:191], v[208:211]
    ds_read_b128 v[140:143], v9 offset:18432
    v_mfma_f32_16x16x32_bf16 v[212:215], v[16:19], v[188:191], v[212:215]
    v_mfma_f32_16x16x32_bf16 v[216:219], v[18:21], v[196:199], v[216:219]
    v_mfma_f32_16x16x32_bf16 v[220:223], v[16:19], v[196:199], v[220:223]
    v_mfma_f32_16x16x32_bf16 v[60:63], v[236:239], v[160:163], v[60:63]
    v_mfma_f32_16x16x32_bf16 v[64:67], v[232:235], v[164:167], v[64:67]
    v_mfma_f32_16x16x32_bf16 v[68:71], v[236:239], v[164:167], v[68:71]
    v_mfma_f32_16x16x32_bf16 v[72:75], v[232:235], v[168:171], v[72:75]
    v_cvt_pk_bf16_f32 v224, v208, v209
    v_cvt_pk_bf16_f32 v225, v210, v211
    v_mfma_f32_16x16x32_bf16 v[76:79], v[236:239], v[168:171], v[76:79]
    v_cvt_pk_bf16_f32 v226, v212, v213
    v_cvt_pk_bf16_f32 v227, v214, v215
    v_mfma_f32_16x16x32_bf16 v[80:83], v[232:235], v[172:175], v[80:83]
    v_cvt_pk_bf16_f32 v228, v216, v217
    v_cvt_pk_bf16_f32 v229, v218, v219
    v_mfma_f32_16x16x32_bf16 v[84:87], v[236:239], v[172:175], v[84:87]
    v_cvt_pk_bf16_f32 v230, v220, v221
    v_cvt_pk_bf16_f32 v231, v222, v223
    v_mfma_f32_16x16x32_bf16 v[88:91], v[232:235], v[176:179], v[88:91]
    v_mfma_f32_16x16x32_bf16 v[92:95], v[236:239], v[176:179], v[92:95]
    v_mfma_f32_16x16x32_bf16 v[96:99], v[232:235], v[180:183], v[96:99]
    v_mfma_f32_16x16x32_bf16 v[100:103], v[236:239], v[180:183], v[100:103]
    s_waitcnt lgkmcnt(0)
    v_mfma_f32_16x16x32_bf16 v[24:27], v[224:227], v[104:107], v[24:27]
    ds_read_b128 v[184:187], v8 offset:0
    v_mfma_f32_16x16x32_bf16 v[28:31], v[228:231], v[104:107], v[28:31]
    ds_read_b128 v[188:191], v8 offset:16384
    v_mfma_f32_16x16x32_bf16 v[32:35], v[224:227], v[108:111], v[32:35]
    ds_read_b128 v[192:195], v8 offset:2048
    v_mfma_f32_16x16x32_bf16 v[36:39], v[228:231], v[108:111], v[36:39]
    ds_read_b128 v[196:199], v8 offset:18432
    v_mfma_f32_16x16x32_bf16 v[40:43], v[224:227], v[112:115], v[40:43]
    ds_read_b128 v[144:147], v10 offset:0
    v_mfma_f32_16x16x32_bf16 v[44:47], v[228:231], v[112:115], v[44:47]
    ds_read_b128 v[148:151], v10 offset:2048
    v_mfma_f32_16x16x32_bf16 v[48:51], v[224:227], v[116:119], v[48:51]
    ds_read_b128 v[152:155], v10 offset:4096
    v_mfma_f32_16x16x32_bf16 v[52:55], v[228:231], v[116:119], v[52:55]
    ds_read_b128 v[156:159], v10 offset:6144
    v_mfma_f32_16x16x32_bf16 v[56:59], v[224:227], v[120:123], v[56:59]
    ds_read_b128 v[160:163], v10 offset:8192
    s_waitcnt lgkmcnt(5)
    v_mfma_f32_16x16x32_bf16 v[208:211], v[14:17], v[184:187], 0
    ds_read_b128 v[164:167], v10 offset:10240
    v_mfma_f32_16x16x32_bf16 v[212:215], v[12:15], v[184:187], 0
    ds_read_b128 v[168:171], v10 offset:12288
    v_mfma_f32_16x16x32_bf16 v[216:219], v[14:17], v[192:195], 0
    ds_read_b128 v[172:175], v10 offset:14336
    v_mfma_f32_16x16x32_bf16 v[220:223], v[12:15], v[192:195], 0
    ds_read_b128 v[176:179], v10 offset:16384
    v_mfma_f32_16x16x32_bf16 v[208:211], v[18:21], v[188:191], v[208:211]
    ds_read_b128 v[180:183], v10 offset:18432
    v_mfma_f32_16x16x32_bf16 v[212:215], v[16:19], v[188:191], v[212:215]
    v_mfma_f32_16x16x32_bf16 v[216:219], v[18:21], v[196:199], v[216:219]
    v_mfma_f32_16x16x32_bf16 v[220:223], v[16:19], v[196:199], v[220:223]
    v_mfma_f32_16x16x32_bf16 v[60:63], v[228:231], v[120:123], v[60:63]
    v_mfma_f32_16x16x32_bf16 v[64:67], v[224:227], v[124:127], v[64:67]
    v_mfma_f32_16x16x32_bf16 v[68:71], v[228:231], v[124:127], v[68:71]
    v_mfma_f32_16x16x32_bf16 v[72:75], v[224:227], v[128:131], v[72:75]
    v_cvt_pk_bf16_f32 v232, v208, v209
    v_cvt_pk_bf16_f32 v233, v210, v211
    v_mfma_f32_16x16x32_bf16 v[76:79], v[228:231], v[128:131], v[76:79]
    v_cvt_pk_bf16_f32 v234, v212, v213
    v_cvt_pk_bf16_f32 v235, v214, v215
    v_mfma_f32_16x16x32_bf16 v[80:83], v[224:227], v[132:135], v[80:83]
    v_cvt_pk_bf16_f32 v236, v216, v217
    v_cvt_pk_bf16_f32 v237, v218, v219
    v_mfma_f32_16x16x32_bf16 v[84:87], v[228:231], v[132:135], v[84:87]
    v_cvt_pk_bf16_f32 v238, v220, v221
    v_cvt_pk_bf16_f32 v239, v222, v223
    v_mfma_f32_16x16x32_bf16 v[88:91], v[224:227], v[136:139], v[88:91]
    v_mfma_f32_16x16x32_bf16 v[92:95], v[228:231], v[136:139], v[92:95]
    v_mfma_f32_16x16x32_bf16 v[96:99], v[224:227], v[140:143], v[96:99]
    v_mfma_f32_16x16x32_bf16 v[100:103], v[228:231], v[140:143], v[100:103]
    s_waitcnt lgkmcnt(0)
    v_subrev_u32 v7, 106496, v7
    v_subrev_u32 v8, 106496, v8
    v_subrev_u32 v9, 106496, v9
    v_subrev_u32 v10, 106496, v10
    s_barrier
    v_mfma_f32_16x16x32_bf16 v[24:27], v[232:235], v[144:147], v[24:27]
    ds_read_b128 v[184:187], v7 offset:0
    v_mfma_f32_16x16x32_bf16 v[28:31], v[236:239], v[144:147], v[28:31]
    ds_read_b128 v[188:191], v7 offset:16384
    v_mfma_f32_16x16x32_bf16 v[32:35], v[232:235], v[148:151], v[32:35]
    ds_read_b128 v[192:195], v7 offset:2048
    v_mfma_f32_16x16x32_bf16 v[36:39], v[236:239], v[148:151], v[36:39]
    ds_read_b128 v[196:199], v7 offset:18432
    v_mfma_f32_16x16x32_bf16 v[40:43], v[232:235], v[152:155], v[40:43]
    ds_read_b128 v[104:107], v9 offset:0
    v_mfma_f32_16x16x32_bf16 v[44:47], v[236:239], v[152:155], v[44:47]
    ds_read_b128 v[108:111], v9 offset:2048
    v_mfma_f32_16x16x32_bf16 v[48:51], v[232:235], v[156:159], v[48:51]
    ds_read_b128 v[112:115], v9 offset:4096
    v_mfma_f32_16x16x32_bf16 v[52:55], v[236:239], v[156:159], v[52:55]
    ds_read_b128 v[116:119], v9 offset:6144
    v_mfma_f32_16x16x32_bf16 v[56:59], v[232:235], v[160:163], v[56:59]
    ds_read_b128 v[120:123], v9 offset:8192
    s_waitcnt lgkmcnt(5)
    v_mfma_f32_16x16x32_bf16 v[208:211], v[14:17], v[184:187], 0
    ds_read_b128 v[124:127], v9 offset:10240
    v_mfma_f32_16x16x32_bf16 v[212:215], v[12:15], v[184:187], 0
    ds_read_b128 v[128:131], v9 offset:12288
    v_mfma_f32_16x16x32_bf16 v[216:219], v[14:17], v[192:195], 0
    ds_read_b128 v[132:135], v9 offset:14336
    v_mfma_f32_16x16x32_bf16 v[220:223], v[12:15], v[192:195], 0
    ds_read_b128 v[136:139], v9 offset:16384
    v_mfma_f32_16x16x32_bf16 v[208:211], v[18:21], v[188:191], v[208:211]
    ds_read_b128 v[140:143], v9 offset:18432
    v_mfma_f32_16x16x32_bf16 v[212:215], v[16:19], v[188:191], v[212:215]
    v_mfma_f32_16x16x32_bf16 v[216:219], v[18:21], v[196:199], v[216:219]
    v_mfma_f32_16x16x32_bf16 v[220:223], v[16:19], v[196:199], v[220:223]
    v_mfma_f32_16x16x32_bf16 v[60:63], v[236:239], v[160:163], v[60:63]
    v_mfma_f32_16x16x32_bf16 v[64:67], v[232:235], v[164:167], v[64:67]
    v_mfma_f32_16x16x32_bf16 v[68:71], v[236:239], v[164:167], v[68:71]
    v_mfma_f32_16x16x32_bf16 v[72:75], v[232:235], v[168:171], v[72:75]
    v_cvt_pk_bf16_f32 v224, v208, v209
    v_cvt_pk_bf16_f32 v225, v210, v211
    v_mfma_f32_16x16x32_bf16 v[76:79], v[236:239], v[168:171], v[76:79]
    v_cvt_pk_bf16_f32 v226, v212, v213
    v_cvt_pk_bf16_f32 v227, v214, v215
    v_mfma_f32_16x16x32_bf16 v[80:83], v[232:235], v[172:175], v[80:83]
    v_cvt_pk_bf16_f32 v228, v216, v217
    v_cvt_pk_bf16_f32 v229, v218, v219
    v_mfma_f32_16x16x32_bf16 v[84:87], v[236:239], v[172:175], v[84:87]
    v_cvt_pk_bf16_f32 v230, v220, v221
    v_cvt_pk_bf16_f32 v231, v222, v223
    v_mfma_f32_16x16x32_bf16 v[88:91], v[232:235], v[176:179], v[88:91]
    v_mfma_f32_16x16x32_bf16 v[92:95], v[236:239], v[176:179], v[92:95]
    v_mfma_f32_16x16x32_bf16 v[96:99], v[232:235], v[180:183], v[96:99]
    v_mfma_f32_16x16x32_bf16 v[100:103], v[236:239], v[180:183], v[100:103]
    s_waitcnt lgkmcnt(0)
    v_mfma_f32_16x16x32_bf16 v[24:27], v[224:227], v[104:107], v[24:27]
    ds_read_b128 v[184:187], v8 offset:0
    v_mfma_f32_16x16x32_bf16 v[28:31], v[228:231], v[104:107], v[28:31]
    ds_read_b128 v[188:191], v8 offset:16384
    v_mfma_f32_16x16x32_bf16 v[32:35], v[224:227], v[108:111], v[32:35]
    ds_read_b128 v[192:195], v8 offset:2048
    v_mfma_f32_16x16x32_bf16 v[36:39], v[228:231], v[108:111], v[36:39]
    ds_read_b128 v[196:199], v8 offset:18432
    v_mfma_f32_16x16x32_bf16 v[40:43], v[224:227], v[112:115], v[40:43]
    ds_read_b128 v[144:147], v10 offset:0
    v_mfma_f32_16x16x32_bf16 v[44:47], v[228:231], v[112:115], v[44:47]
    ds_read_b128 v[148:151], v10 offset:2048
    v_mfma_f32_16x16x32_bf16 v[48:51], v[224:227], v[116:119], v[48:51]
    ds_read_b128 v[152:155], v10 offset:4096
    v_mfma_f32_16x16x32_bf16 v[52:55], v[228:231], v[116:119], v[52:55]
    ds_read_b128 v[156:159], v10 offset:6144
    v_mfma_f32_16x16x32_bf16 v[56:59], v[224:227], v[120:123], v[56:59]
    ds_read_b128 v[160:163], v10 offset:8192
    s_waitcnt lgkmcnt(5)
    v_mfma_f32_16x16x32_bf16 v[208:211], v[14:17], v[184:187], 0
    ds_read_b128 v[164:167], v10 offset:10240
    v_mfma_f32_16x16x32_bf16 v[212:215], v[12:15], v[184:187], 0
    ds_read_b128 v[168:171], v10 offset:12288
    v_mfma_f32_16x16x32_bf16 v[216:219], v[14:17], v[192:195], 0
    ds_read_b128 v[172:175], v10 offset:14336
    v_mfma_f32_16x16x32_bf16 v[220:223], v[12:15], v[192:195], 0
    ds_read_b128 v[176:179], v10 offset:16384
    v_mfma_f32_16x16x32_bf16 v[208:211], v[18:21], v[188:191], v[208:211]
    ds_read_b128 v[180:183], v10 offset:18432
    v_mfma_f32_16x16x32_bf16 v[212:215], v[16:19], v[188:191], v[212:215]
    v_mfma_f32_16x16x32_bf16 v[216:219], v[18:21], v[196:199], v[216:219]
    v_mfma_f32_16x16x32_bf16 v[220:223], v[16:19], v[196:199], v[220:223]
    v_mfma_f32_16x16x32_bf16 v[60:63], v[228:231], v[120:123], v[60:63]
    v_mfma_f32_16x16x32_bf16 v[64:67], v[224:227], v[124:127], v[64:67]
    v_mfma_f32_16x16x32_bf16 v[68:71], v[228:231], v[124:127], v[68:71]
    v_mfma_f32_16x16x32_bf16 v[72:75], v[224:227], v[128:131], v[72:75]
    v_cvt_pk_bf16_f32 v232, v208, v209
    v_cvt_pk_bf16_f32 v233, v210, v211
    v_mfma_f32_16x16x32_bf16 v[76:79], v[228:231], v[128:131], v[76:79]
    v_cvt_pk_bf16_f32 v234, v212, v213
    v_cvt_pk_bf16_f32 v235, v214, v215
    v_mfma_f32_16x16x32_bf16 v[80:83], v[224:227], v[132:135], v[80:83]
    v_cvt_pk_bf16_f32 v236, v216, v217
    v_cvt_pk_bf16_f32 v237, v218, v219
    v_mfma_f32_16x16x32_bf16 v[84:87], v[228:231], v[132:135], v[84:87]
    v_cvt_pk_bf16_f32 v238, v220, v221
    v_cvt_pk_bf16_f32 v239, v222, v223
    v_mfma_f32_16x16x32_bf16 v[88:91], v[224:227], v[136:139], v[88:91]
    v_mfma_f32_16x16x32_bf16 v[92:95], v[228:231], v[136:139], v[92:95]
    v_mfma_f32_16x16x32_bf16 v[96:99], v[224:227], v[140:143], v[96:99]
    v_mfma_f32_16x16x32_bf16 v[100:103], v[228:231], v[140:143], v[100:103]
    s_waitcnt lgkmcnt(0)
    v_add_u32 v7, 53248, v7
    v_add_u32 v8, 53248, v8
    v_add_u32 v9, 53248, v9
    v_add_u32 v10, 53248, v10
    s_barrier
    v_mfma_f32_16x16x32_bf16 v[24:27], v[232:235], v[144:147], v[24:27]
    ds_read_b128 v[184:187], v7 offset:0
    v_mfma_f32_16x16x32_bf16 v[28:31], v[236:239], v[144:147], v[28:31]
    ds_read_b128 v[188:191], v7 offset:16384
    v_mfma_f32_16x16x32_bf16 v[32:35], v[232:235], v[148:151], v[32:35]
    ds_read_b128 v[192:195], v7 offset:2048
    v_mfma_f32_16x16x32_bf16 v[36:39], v[236:239], v[148:151], v[36:39]
    ds_read_b128 v[196:199], v7 offset:18432
    v_mfma_f32_16x16x32_bf16 v[40:43], v[232:235], v[152:155], v[40:43]
    ds_read_b128 v[104:107], v9 offset:0
    v_mfma_f32_16x16x32_bf16 v[44:47], v[236:239], v[152:155], v[44:47]
    ds_read_b128 v[108:111], v9 offset:2048
    v_mfma_f32_16x16x32_bf16 v[48:51], v[232:235], v[156:159], v[48:51]
    ds_read_b128 v[112:115], v9 offset:4096
    v_mfma_f32_16x16x32_bf16 v[52:55], v[236:239], v[156:159], v[52:55]
    ds_read_b128 v[116:119], v9 offset:6144
    v_mfma_f32_16x16x32_bf16 v[56:59], v[232:235], v[160:163], v[56:59]
    ds_read_b128 v[120:123], v9 offset:8192
    s_waitcnt lgkmcnt(5)
    v_mfma_f32_16x16x32_bf16 v[208:211], v[14:17], v[184:187], 0
    ds_read_b128 v[124:127], v9 offset:10240
    v_mfma_f32_16x16x32_bf16 v[212:215], v[12:15], v[184:187], 0
    ds_read_b128 v[128:131], v9 offset:12288
    v_mfma_f32_16x16x32_bf16 v[216:219], v[14:17], v[192:195], 0
    ds_read_b128 v[132:135], v9 offset:14336
    v_mfma_f32_16x16x32_bf16 v[220:223], v[12:15], v[192:195], 0
    ds_read_b128 v[136:139], v9 offset:16384
    v_mfma_f32_16x16x32_bf16 v[208:211], v[18:21], v[188:191], v[208:211]
    ds_read_b128 v[140:143], v9 offset:18432
    v_mfma_f32_16x16x32_bf16 v[212:215], v[16:19], v[188:191], v[212:215]
    v_mfma_f32_16x16x32_bf16 v[216:219], v[18:21], v[196:199], v[216:219]
    v_mfma_f32_16x16x32_bf16 v[220:223], v[16:19], v[196:199], v[220:223]
    v_mfma_f32_16x16x32_bf16 v[60:63], v[236:239], v[160:163], v[60:63]
    v_mfma_f32_16x16x32_bf16 v[64:67], v[232:235], v[164:167], v[64:67]
    v_mfma_f32_16x16x32_bf16 v[68:71], v[236:239], v[164:167], v[68:71]
    v_mfma_f32_16x16x32_bf16 v[72:75], v[232:235], v[168:171], v[72:75]
    v_cvt_pk_bf16_f32 v224, v208, v209
    v_cvt_pk_bf16_f32 v225, v210, v211
    v_mfma_f32_16x16x32_bf16 v[76:79], v[236:239], v[168:171], v[76:79]
    v_cvt_pk_bf16_f32 v226, v212, v213
    v_cvt_pk_bf16_f32 v227, v214, v215
    v_mfma_f32_16x16x32_bf16 v[80:83], v[232:235], v[172:175], v[80:83]
    v_cvt_pk_bf16_f32 v228, v216, v217
    v_cvt_pk_bf16_f32 v229, v218, v219
    v_mfma_f32_16x16x32_bf16 v[84:87], v[236:239], v[172:175], v[84:87]
    v_cvt_pk_bf16_f32 v230, v220, v221
    v_cvt_pk_bf16_f32 v231, v222, v223
    v_mfma_f32_16x16x32_bf16 v[88:91], v[232:235], v[176:179], v[88:91]
    v_mfma_f32_16x16x32_bf16 v[92:95], v[236:239], v[176:179], v[92:95]
    v_mfma_f32_16x16x32_bf16 v[96:99], v[232:235], v[180:183], v[96:99]
    v_mfma_f32_16x16x32_bf16 v[100:103], v[236:239], v[180:183], v[100:103]
    s_waitcnt lgkmcnt(0)
    v_mfma_f32_16x16x32_bf16 v[24:27], v[224:227], v[104:107], v[24:27]
    ds_read_b128 v[184:187], v8 offset:0
    v_mfma_f32_16x16x32_bf16 v[28:31], v[228:231], v[104:107], v[28:31]
    ds_read_b128 v[188:191], v8 offset:16384
    v_mfma_f32_16x16x32_bf16 v[32:35], v[224:227], v[108:111], v[32:35]
    ds_read_b128 v[192:195], v8 offset:2048
    v_mfma_f32_16x16x32_bf16 v[36:39], v[228:231], v[108:111], v[36:39]
    ds_read_b128 v[196:199], v8 offset:18432
    v_mfma_f32_16x16x32_bf16 v[40:43], v[224:227], v[112:115], v[40:43]
    ds_read_b128 v[144:147], v10 offset:0
    v_mfma_f32_16x16x32_bf16 v[44:47], v[228:231], v[112:115], v[44:47]
    ds_read_b128 v[148:151], v10 offset:2048
    v_mfma_f32_16x16x32_bf16 v[48:51], v[224:227], v[116:119], v[48:51]
    ds_read_b128 v[152:155], v10 offset:4096
    v_mfma_f32_16x16x32_bf16 v[52:55], v[228:231], v[116:119], v[52:55]
    ds_read_b128 v[156:159], v10 offset:6144
    v_mfma_f32_16x16x32_bf16 v[56:59], v[224:227], v[120:123], v[56:59]
    ds_read_b128 v[160:163], v10 offset:8192
    s_waitcnt lgkmcnt(5)
    v_mfma_f32_16x16x32_bf16 v[208:211], v[14:17], v[184:187], 0
    ds_read_b128 v[164:167], v10 offset:10240
    v_mfma_f32_16x16x32_bf16 v[212:215], v[12:15], v[184:187], 0
    ds_read_b128 v[168:171], v10 offset:12288
    v_mfma_f32_16x16x32_bf16 v[216:219], v[14:17], v[192:195], 0
    ds_read_b128 v[172:175], v10 offset:14336
    v_mfma_f32_16x16x32_bf16 v[220:223], v[12:15], v[192:195], 0
    ds_read_b128 v[176:179], v10 offset:16384
    v_mfma_f32_16x16x32_bf16 v[208:211], v[18:21], v[188:191], v[208:211]
    ds_read_b128 v[180:183], v10 offset:18432
    v_mfma_f32_16x16x32_bf16 v[212:215], v[16:19], v[188:191], v[212:215]
    v_mfma_f32_16x16x32_bf16 v[216:219], v[18:21], v[196:199], v[216:219]
    v_mfma_f32_16x16x32_bf16 v[220:223], v[16:19], v[196:199], v[220:223]
    v_mfma_f32_16x16x32_bf16 v[60:63], v[228:231], v[120:123], v[60:63]
    v_mfma_f32_16x16x32_bf16 v[64:67], v[224:227], v[124:127], v[64:67]
    v_mfma_f32_16x16x32_bf16 v[68:71], v[228:231], v[124:127], v[68:71]
    v_mfma_f32_16x16x32_bf16 v[72:75], v[224:227], v[128:131], v[72:75]
    v_cvt_pk_bf16_f32 v232, v208, v209
    v_cvt_pk_bf16_f32 v233, v210, v211
    v_mfma_f32_16x16x32_bf16 v[76:79], v[228:231], v[128:131], v[76:79]
    v_cvt_pk_bf16_f32 v234, v212, v213
    v_cvt_pk_bf16_f32 v235, v214, v215
    v_mfma_f32_16x16x32_bf16 v[80:83], v[224:227], v[132:135], v[80:83]
    v_cvt_pk_bf16_f32 v236, v216, v217
    v_cvt_pk_bf16_f32 v237, v218, v219
    v_mfma_f32_16x16x32_bf16 v[84:87], v[228:231], v[132:135], v[84:87]
    v_cvt_pk_bf16_f32 v238, v220, v221
    v_cvt_pk_bf16_f32 v239, v222, v223
    v_mfma_f32_16x16x32_bf16 v[88:91], v[224:227], v[136:139], v[88:91]
    v_mfma_f32_16x16x32_bf16 v[92:95], v[228:231], v[136:139], v[92:95]
    v_mfma_f32_16x16x32_bf16 v[96:99], v[224:227], v[140:143], v[96:99]
    v_mfma_f32_16x16x32_bf16 v[100:103], v[228:231], v[140:143], v[100:103]
    s_waitcnt lgkmcnt(0)
    v_add_u32 v7, 53248, v7
    v_add_u32 v8, 53248, v8
    v_add_u32 v9, 53248, v9
    v_add_u32 v10, 53248, v10
    s_barrier
    v_mfma_f32_16x16x32_bf16 v[24:27], v[232:235], v[144:147], v[24:27]
    ds_read_b128 v[184:187], v7 offset:0
    v_mfma_f32_16x16x32_bf16 v[28:31], v[236:239], v[144:147], v[28:31]
    ds_read_b128 v[188:191], v7 offset:16384
    v_mfma_f32_16x16x32_bf16 v[32:35], v[232:235], v[148:151], v[32:35]
    ds_read_b128 v[192:195], v7 offset:2048
    v_mfma_f32_16x16x32_bf16 v[36:39], v[236:239], v[148:151], v[36:39]
    ds_read_b128 v[196:199], v7 offset:18432
    v_mfma_f32_16x16x32_bf16 v[40:43], v[232:235], v[152:155], v[40:43]
    ds_read_b128 v[104:107], v9 offset:0
    v_mfma_f32_16x16x32_bf16 v[44:47], v[236:239], v[152:155], v[44:47]
    ds_read_b128 v[108:111], v9 offset:2048
    v_mfma_f32_16x16x32_bf16 v[48:51], v[232:235], v[156:159], v[48:51]
    ds_read_b128 v[112:115], v9 offset:4096
    v_mfma_f32_16x16x32_bf16 v[52:55], v[236:239], v[156:159], v[52:55]
    ds_read_b128 v[116:119], v9 offset:6144
    v_mfma_f32_16x16x32_bf16 v[56:59], v[232:235], v[160:163], v[56:59]
    ds_read_b128 v[120:123], v9 offset:8192
    s_waitcnt lgkmcnt(5)
    v_mfma_f32_16x16x32_bf16 v[208:211], v[14:17], v[184:187], 0
    ds_read_b128 v[124:127], v9 offset:10240
    v_mfma_f32_16x16x32_bf16 v[212:215], v[12:15], v[184:187], 0
    ds_read_b128 v[128:131], v9 offset:12288
    v_mfma_f32_16x16x32_bf16 v[216:219], v[14:17], v[192:195], 0
    ds_read_b128 v[132:135], v9 offset:14336
    v_mfma_f32_16x16x32_bf16 v[220:223], v[12:15], v[192:195], 0
    ds_read_b128 v[136:139], v9 offset:16384
    v_mfma_f32_16x16x32_bf16 v[208:211], v[18:21], v[188:191], v[208:211]
    ds_read_b128 v[140:143], v9 offset:18432
    v_mfma_f32_16x16x32_bf16 v[212:215], v[16:19], v[188:191], v[212:215]
    v_mfma_f32_16x16x32_bf16 v[216:219], v[18:21], v[196:199], v[216:219]
    v_mfma_f32_16x16x32_bf16 v[220:223], v[16:19], v[196:199], v[220:223]
    v_mfma_f32_16x16x32_bf16 v[60:63], v[236:239], v[160:163], v[60:63]
    v_mfma_f32_16x16x32_bf16 v[64:67], v[232:235], v[164:167], v[64:67]
    v_mfma_f32_16x16x32_bf16 v[68:71], v[236:239], v[164:167], v[68:71]
    v_mfma_f32_16x16x32_bf16 v[72:75], v[232:235], v[168:171], v[72:75]
    v_cvt_pk_bf16_f32 v224, v208, v209
    v_cvt_pk_bf16_f32 v225, v210, v211
    v_mfma_f32_16x16x32_bf16 v[76:79], v[236:239], v[168:171], v[76:79]
    v_cvt_pk_bf16_f32 v226, v212, v213
    v_cvt_pk_bf16_f32 v227, v214, v215
    v_mfma_f32_16x16x32_bf16 v[80:83], v[232:235], v[172:175], v[80:83]
    v_cvt_pk_bf16_f32 v228, v216, v217
    v_cvt_pk_bf16_f32 v229, v218, v219
    v_mfma_f32_16x16x32_bf16 v[84:87], v[236:239], v[172:175], v[84:87]
    v_cvt_pk_bf16_f32 v230, v220, v221
    v_cvt_pk_bf16_f32 v231, v222, v223
    v_mfma_f32_16x16x32_bf16 v[88:91], v[232:235], v[176:179], v[88:91]
    v_mfma_f32_16x16x32_bf16 v[92:95], v[236:239], v[176:179], v[92:95]
    v_mfma_f32_16x16x32_bf16 v[96:99], v[232:235], v[180:183], v[96:99]
    v_mfma_f32_16x16x32_bf16 v[100:103], v[236:239], v[180:183], v[100:103]
    s_waitcnt lgkmcnt(0)
    v_mfma_f32_16x16x32_bf16 v[24:27], v[224:227], v[104:107], v[24:27]
    ds_read_b128 v[184:187], v8 offset:0
    v_mfma_f32_16x16x32_bf16 v[28:31], v[228:231], v[104:107], v[28:31]
    ds_read_b128 v[188:191], v8 offset:16384
    v_mfma_f32_16x16x32_bf16 v[32:35], v[224:227], v[108:111], v[32:35]
    ds_read_b128 v[192:195], v8 offset:2048
    v_mfma_f32_16x16x32_bf16 v[36:39], v[228:231], v[108:111], v[36:39]
    ds_read_b128 v[196:199], v8 offset:18432
    v_mfma_f32_16x16x32_bf16 v[40:43], v[224:227], v[112:115], v[40:43]
    ds_read_b128 v[144:147], v10 offset:0
    v_mfma_f32_16x16x32_bf16 v[44:47], v[228:231], v[112:115], v[44:47]
    ds_read_b128 v[148:151], v10 offset:2048
    v_mfma_f32_16x16x32_bf16 v[48:51], v[224:227], v[116:119], v[48:51]
    ds_read_b128 v[152:155], v10 offset:4096
    v_mfma_f32_16x16x32_bf16 v[52:55], v[228:231], v[116:119], v[52:55]
    ds_read_b128 v[156:159], v10 offset:6144
    v_mfma_f32_16x16x32_bf16 v[56:59], v[224:227], v[120:123], v[56:59]
    ds_read_b128 v[160:163], v10 offset:8192
    s_waitcnt lgkmcnt(5)
    v_mfma_f32_16x16x32_bf16 v[208:211], v[14:17], v[184:187], 0
    ds_read_b128 v[164:167], v10 offset:10240
    v_mfma_f32_16x16x32_bf16 v[212:215], v[12:15], v[184:187], 0
    ds_read_b128 v[168:171], v10 offset:12288
    v_mfma_f32_16x16x32_bf16 v[216:219], v[14:17], v[192:195], 0
    ds_read_b128 v[172:175], v10 offset:14336
    v_mfma_f32_16x16x32_bf16 v[220:223], v[12:15], v[192:195], 0
    ds_read_b128 v[176:179], v10 offset:16384
    v_mfma_f32_16x16x32_bf16 v[208:211], v[18:21], v[188:191], v[208:211]
    ds_read_b128 v[180:183], v10 offset:18432
    v_mfma_f32_16x16x32_bf16 v[212:215], v[16:19], v[188:191], v[212:215]
    v_mfma_f32_16x16x32_bf16 v[216:219], v[18:21], v[196:199], v[216:219]
    v_mfma_f32_16x16x32_bf16 v[220:223], v[16:19], v[196:199], v[220:223]
    v_mfma_f32_16x16x32_bf16 v[60:63], v[228:231], v[120:123], v[60:63]
    v_mfma_f32_16x16x32_bf16 v[64:67], v[224:227], v[124:127], v[64:67]
    v_mfma_f32_16x16x32_bf16 v[68:71], v[228:231], v[124:127], v[68:71]
    v_mfma_f32_16x16x32_bf16 v[72:75], v[224:227], v[128:131], v[72:75]
    v_cvt_pk_bf16_f32 v232, v208, v209
    v_cvt_pk_bf16_f32 v233, v210, v211
    v_mfma_f32_16x16x32_bf16 v[76:79], v[228:231], v[128:131], v[76:79]
    v_cvt_pk_bf16_f32 v234, v212, v213
    v_cvt_pk_bf16_f32 v235, v214, v215
    v_mfma_f32_16x16x32_bf16 v[80:83], v[224:227], v[132:135], v[80:83]
    v_cvt_pk_bf16_f32 v236, v216, v217
    v_cvt_pk_bf16_f32 v237, v218, v219
    v_mfma_f32_16x16x32_bf16 v[84:87], v[228:231], v[132:135], v[84:87]
    v_cvt_pk_bf16_f32 v238, v220, v221
    v_cvt_pk_bf16_f32 v239, v222, v223
    v_mfma_f32_16x16x32_bf16 v[88:91], v[224:227], v[136:139], v[88:91]
    v_mfma_f32_16x16x32_bf16 v[92:95], v[228:231], v[136:139], v[92:95]
    v_mfma_f32_16x16x32_bf16 v[96:99], v[224:227], v[140:143], v[96:99]
    v_mfma_f32_16x16x32_bf16 v[100:103], v[228:231], v[140:143], v[100:103]
    s_waitcnt lgkmcnt(0)
    s_barrier
    v_mfma_f32_16x16x32_bf16 v[24:27], v[232:235], v[144:147], v[24:27]
    v_mfma_f32_16x16x32_bf16 v[28:31], v[236:239], v[144:147], v[28:31]
    v_mfma_f32_16x16x32_bf16 v[32:35], v[232:235], v[148:151], v[32:35]
    v_mfma_f32_16x16x32_bf16 v[36:39], v[236:239], v[148:151], v[36:39]
    v_mfma_f32_16x16x32_bf16 v[40:43], v[232:235], v[152:155], v[40:43]
    v_mfma_f32_16x16x32_bf16 v[44:47], v[236:239], v[152:155], v[44:47]
    v_mfma_f32_16x16x32_bf16 v[48:51], v[232:235], v[156:159], v[48:51]
    v_mfma_f32_16x16x32_bf16 v[52:55], v[236:239], v[156:159], v[52:55]
    v_mfma_f32_16x16x32_bf16 v[56:59], v[232:235], v[160:163], v[56:59]
    v_mfma_f32_16x16x32_bf16 v[60:63], v[236:239], v[160:163], v[60:63]
    v_mfma_f32_16x16x32_bf16 v[64:67], v[232:235], v[164:167], v[64:67]
    v_mfma_f32_16x16x32_bf16 v[68:71], v[236:239], v[164:167], v[68:71]
    v_mfma_f32_16x16x32_bf16 v[72:75], v[232:235], v[168:171], v[72:75]
    v_mfma_f32_16x16x32_bf16 v[76:79], v[236:239], v[168:171], v[76:79]
    v_mfma_f32_16x16x32_bf16 v[80:83], v[232:235], v[172:175], v[80:83]
    v_mfma_f32_16x16x32_bf16 v[84:87], v[236:239], v[172:175], v[84:87]
    v_mfma_f32_16x16x32_bf16 v[88:91], v[232:235], v[176:179], v[88:91]
    v_mfma_f32_16x16x32_bf16 v[92:95], v[236:239], v[176:179], v[92:95]
    v_mfma_f32_16x16x32_bf16 v[96:99], v[232:235], v[180:183], v[96:99]
    v_mfma_f32_16x16x32_bf16 v[100:103], v[236:239], v[180:183], v[100:103]
    v_and_b32 v4, 1, v0
    v_cmp_eq_u32 vcc, 1, v4
    s_mul_i32 s59, s51, 10240
    v_lshlrev_b32 v5, 4, v0
    v_add_u32 v5, 102400, v5
    v_add_u32 v6, s59, v5
    v_cndmask_b32_e64 v184, v200, v204, vcc
    v_xor_b32 v204, 0x80008000, v204
    v_cndmask_b32_e64 v188, v204, v200, vcc
    v_cndmask_b32_e64 v185, v201, v205, vcc
    v_xor_b32 v205, 0x80008000, v205
    v_cndmask_b32_e64 v189, v205, v201, vcc
    v_cndmask_b32_e64 v186, v202, v206, vcc
    v_xor_b32 v206, 0x80008000, v206
    v_cndmask_b32_e64 v190, v206, v202, vcc
    v_cndmask_b32_e64 v187, v203, v207, vcc
    v_xor_b32 v207, 0x80008000, v207
    v_cndmask_b32_e64 v191, v207, v203, vcc
    v_cvt_pk_bf16_f32 v104, v24, v25
    v_cvt_pk_bf16_f32 v105, v26, v27
    v_cvt_pk_bf16_f32 v106, v28, v29
    v_cvt_pk_bf16_f32 v107, v30, v31
    ds_write_b128 v6, v[104:107] offset:0
    v_cvt_pk_bf16_f32 v108, v32, v33
    v_cvt_pk_bf16_f32 v109, v34, v35
    v_cvt_pk_bf16_f32 v110, v36, v37
    v_cvt_pk_bf16_f32 v111, v38, v39
    ds_write_b128 v6, v[108:111] offset:1024
    v_cvt_pk_bf16_f32 v112, v40, v41
    v_cvt_pk_bf16_f32 v113, v42, v43
    v_cvt_pk_bf16_f32 v114, v44, v45
    v_cvt_pk_bf16_f32 v115, v46, v47
    ds_write_b128 v6, v[112:115] offset:2048
    v_cvt_pk_bf16_f32 v116, v48, v49
    v_cvt_pk_bf16_f32 v117, v50, v51
    v_cvt_pk_bf16_f32 v118, v52, v53
    v_cvt_pk_bf16_f32 v119, v54, v55
    ds_write_b128 v6, v[116:119] offset:3072
    v_cvt_pk_bf16_f32 v120, v56, v57
    v_cvt_pk_bf16_f32 v121, v58, v59
    v_cvt_pk_bf16_f32 v122, v60, v61
    v_cvt_pk_bf16_f32 v123, v62, v63
    ds_write_b128 v6, v[120:123] offset:4096
    v_cvt_pk_bf16_f32 v124, v64, v65
    v_cvt_pk_bf16_f32 v125, v66, v67
    v_cvt_pk_bf16_f32 v126, v68, v69
    v_cvt_pk_bf16_f32 v127, v70, v71
    ds_write_b128 v6, v[124:127] offset:5120
    v_cvt_pk_bf16_f32 v128, v72, v73
    v_cvt_pk_bf16_f32 v129, v74, v75
    v_cvt_pk_bf16_f32 v130, v76, v77
    v_cvt_pk_bf16_f32 v131, v78, v79
    ds_write_b128 v6, v[128:131] offset:6144
    v_cvt_pk_bf16_f32 v132, v80, v81
    v_cvt_pk_bf16_f32 v133, v82, v83
    v_cvt_pk_bf16_f32 v134, v84, v85
    v_cvt_pk_bf16_f32 v135, v86, v87
    ds_write_b128 v6, v[132:135] offset:7168
    v_cvt_pk_bf16_f32 v136, v88, v89
    v_cvt_pk_bf16_f32 v137, v90, v91
    v_cvt_pk_bf16_f32 v138, v92, v93
    v_cvt_pk_bf16_f32 v139, v94, v95
    ds_write_b128 v6, v[136:139] offset:8192
    v_cvt_pk_bf16_f32 v140, v96, v97
    v_cvt_pk_bf16_f32 v141, v98, v99
    v_cvt_pk_bf16_f32 v142, v100, v101
    v_cvt_pk_bf16_f32 v143, v102, v103
    ds_write_b128 v6, v[140:143] offset:9216
    s_lshl_b32 s59, s51, 7
    s_lshl_b32 s60, s56, 1
    s_add_u32 s59, s59, s60
    s_add_u32 s59, s59, s48
    s_mul_i32 s59, s59, 5376
    s_add_u32 s59, s59, 2621440
    v_mul_u32_u24 v9, 172032, v3
    v_add_u32 v9, s59, v9
    s_and_b32 s59, s49, 1
    s_mul_i32 s59, s59, 2688
    s_lshr_b32 s60, s49, 1
    s_mul_i32 s60, s60, 1280
    s_add_u32 s60, s60, s59
    v_lshl_add_u32 v8, v2, 4, v9
    v_add_u32 v8, s60, v8
    v_add_u32 v9, 2560, v9
    v_mov_b32 v7, 2147483648
    v_cndmask_b32 v9, v7, v9, s[66:67]
    s_mov_b32 s59, 0
    s_mov_b32 s60, 86016
    s_waitcnt lgkmcnt(0)
    s_barrier
    ds_read_b128 v[104:107], v5 offset:1024
    ds_read_b128 v[108:111], v5 offset:6144
    ds_read_b128 v[112:115], v5 offset:11264
    ds_read_b128 v[116:119], v5 offset:16384
    ds_read_b128 v[120:123], v5 offset:21504
    ds_read_b128 v[124:127], v5 offset:26624
    ds_read_b128 v[128:131], v5 offset:31744
    ds_read_b128 v[132:135], v5 offset:36864
    s_waitcnt lgkmcnt(0)
    ds_read_b128 v[144:147], v5 offset:2048
    ds_read_b128 v[148:151], v5 offset:7168
    ds_read_b128 v[152:155], v5 offset:12288
    ds_read_b128 v[156:159], v5 offset:17408
    ds_read_b128 v[160:163], v5 offset:22528
    ds_read_b128 v[164:167], v5 offset:27648
    ds_read_b128 v[168:171], v5 offset:32768
    ds_read_b128 v[172:175], v5 offset:37888
    v_mfma_f32_16x16x32_bf16 v[24:27], v[184:187], v[104:107], 0
    v_mfma_f32_16x16x32_bf16 v[28:31], v[184:187], v[112:115], 0
    v_mfma_f32_16x16x32_bf16 v[32:35], v[184:187], v[120:123], 0
    v_mfma_f32_16x16x32_bf16 v[36:39], v[184:187], v[128:131], 0
    v_mfma_f32_16x16x32_bf16 v[24:27], v[188:191], v[108:111], v[24:27]
    v_mfma_f32_16x16x32_bf16 v[28:31], v[188:191], v[116:119], v[28:31]
    v_mfma_f32_16x16x32_bf16 v[32:35], v[188:191], v[124:127], v[32:35]
    v_mfma_f32_16x16x32_bf16 v[36:39], v[188:191], v[132:135], v[36:39]
    s_waitcnt lgkmcnt(0)
    ds_read_b128 v[104:107], v5 offset:3072
    ds_read_b128 v[108:111], v5 offset:8192
    ds_read_b128 v[112:115], v5 offset:13312
    ds_read_b128 v[116:119], v5 offset:18432
    ds_read_b128 v[120:123], v5 offset:23552
    ds_read_b128 v[124:127], v5 offset:28672
    ds_read_b128 v[128:131], v5 offset:33792
    ds_read_b128 v[132:135], v5 offset:38912
    v_mfma_f32_16x16x32_bf16 v[48:51], v[184:187], v[144:147], 0
    v_mfma_f32_16x16x32_bf16 v[52:55], v[184:187], v[152:155], 0
    v_cvt_pk_bf16_f32 v40, v24, v25
    v_cvt_pk_bf16_f32 v41, v28, v29
    v_mfma_f32_16x16x32_bf16 v[56:59], v[184:187], v[160:163], 0
    v_cvt_pk_bf16_f32 v42, v32, v33
    v_cvt_pk_bf16_f32 v43, v36, v37
    v_mfma_f32_16x16x32_bf16 v[60:63], v[184:187], v[168:171], 0
    buffer_store_dwordx4 v[40:43], v8, s[36:39], s59 offen offset:256 sc1
    v_cvt_pk_bf16_f32 v44, v26, v27
    v_mfma_f32_16x16x32_bf16 v[48:51], v[188:191], v[148:151], v[48:51]
    v_cvt_pk_bf16_f32 v45, v30, v31
    v_cvt_pk_bf16_f32 v46, v34, v35
    v_mfma_f32_16x16x32_bf16 v[52:55], v[188:191], v[156:159], v[52:55]
    v_cvt_pk_bf16_f32 v47, v38, v39
    buffer_store_dwordx4 v[44:47], v8, s[36:39], s60 offen offset:256 sc1
    v_mfma_f32_16x16x32_bf16 v[56:59], v[188:191], v[164:167], v[56:59]
    v_mfma_f32_16x16x32_bf16 v[60:63], v[188:191], v[172:175], v[60:63]
    s_waitcnt lgkmcnt(0)
    ds_read_b128 v[144:147], v5 offset:4096
    ds_read_b128 v[148:151], v5 offset:9216
    ds_read_b128 v[152:155], v5 offset:14336
    ds_read_b128 v[156:159], v5 offset:19456
    ds_read_b128 v[160:163], v5 offset:24576
    ds_read_b128 v[164:167], v5 offset:29696
    ds_read_b128 v[168:171], v5 offset:34816
    ds_read_b128 v[172:175], v5 offset:39936
    v_mfma_f32_16x16x32_bf16 v[72:75], v[184:187], v[104:107], 0
    v_mfma_f32_16x16x32_bf16 v[76:79], v[184:187], v[112:115], 0
    v_cvt_pk_bf16_f32 v64, v48, v49
    v_cvt_pk_bf16_f32 v65, v52, v53
    v_mfma_f32_16x16x32_bf16 v[80:83], v[184:187], v[120:123], 0
    v_cvt_pk_bf16_f32 v66, v56, v57
    v_cvt_pk_bf16_f32 v67, v60, v61
    v_mfma_f32_16x16x32_bf16 v[84:87], v[184:187], v[128:131], 0
    buffer_store_dwordx4 v[64:67], v8, s[36:39], s59 offen offset:512 sc1
    v_cvt_pk_bf16_f32 v68, v50, v51
    v_mfma_f32_16x16x32_bf16 v[72:75], v[188:191], v[108:111], v[72:75]
    v_cvt_pk_bf16_f32 v69, v54, v55
    v_cvt_pk_bf16_f32 v70, v58, v59
    v_mfma_f32_16x16x32_bf16 v[76:79], v[188:191], v[116:119], v[76:79]
    v_cvt_pk_bf16_f32 v71, v62, v63
    buffer_store_dwordx4 v[68:71], v8, s[36:39], s60 offen offset:512 sc1
    v_mfma_f32_16x16x32_bf16 v[80:83], v[188:191], v[124:127], v[80:83]
    v_mfma_f32_16x16x32_bf16 v[84:87], v[188:191], v[132:135], v[84:87]
    s_waitcnt lgkmcnt(0)
    ds_read_b128 v[104:107], v5 offset:0
    ds_read_b128 v[108:111], v5 offset:5120
    ds_read_b128 v[112:115], v5 offset:10240
    ds_read_b128 v[116:119], v5 offset:15360
    ds_read_b128 v[120:123], v5 offset:20480
    ds_read_b128 v[124:127], v5 offset:25600
    ds_read_b128 v[128:131], v5 offset:30720
    ds_read_b128 v[132:135], v5 offset:35840
    v_mfma_f32_16x16x32_bf16 v[24:27], v[184:187], v[144:147], 0
    v_mfma_f32_16x16x32_bf16 v[28:31], v[184:187], v[152:155], 0
    v_cvt_pk_bf16_f32 v88, v72, v73
    v_cvt_pk_bf16_f32 v89, v76, v77
    v_mfma_f32_16x16x32_bf16 v[32:35], v[184:187], v[160:163], 0
    v_cvt_pk_bf16_f32 v90, v80, v81
    v_cvt_pk_bf16_f32 v91, v84, v85
    v_mfma_f32_16x16x32_bf16 v[36:39], v[184:187], v[168:171], 0
    buffer_store_dwordx4 v[88:91], v8, s[36:39], s59 offen offset:768 sc1
    v_cvt_pk_bf16_f32 v92, v74, v75
    v_mfma_f32_16x16x32_bf16 v[24:27], v[188:191], v[148:151], v[24:27]
    v_cvt_pk_bf16_f32 v93, v78, v79
    v_cvt_pk_bf16_f32 v94, v82, v83
    v_mfma_f32_16x16x32_bf16 v[28:31], v[188:191], v[156:159], v[28:31]
    v_cvt_pk_bf16_f32 v95, v86, v87
    buffer_store_dwordx4 v[92:95], v8, s[36:39], s60 offen offset:768 sc1
    v_mfma_f32_16x16x32_bf16 v[32:35], v[188:191], v[164:167], v[32:35]
    v_mfma_f32_16x16x32_bf16 v[36:39], v[188:191], v[172:175], v[36:39]
    s_waitcnt lgkmcnt(0)
    v_mfma_f32_16x16x32_bf16 v[72:75], v[184:187], v[108:111], 0
    v_mfma_f32_16x16x32_bf16 v[76:79], v[184:187], v[116:119], 0
    v_cvt_pk_bf16_f32 v40, v24, v25
    v_cvt_pk_bf16_f32 v41, v28, v29
    v_mfma_f32_16x16x32_bf16 v[80:83], v[184:187], v[124:127], 0
    s_nop 0
    v_cvt_pk_bf16_f32 v42, v32, v33
    v_cvt_pk_bf16_f32 v43, v36, v37
    v_mfma_f32_16x16x32_bf16 v[84:87], v[184:187], v[132:135], 0
    buffer_store_dwordx4 v[40:43], v8, s[36:39], s59 offen offset:1024 sc1
    v_cvt_pk_bf16_f32 v44, v26, v27
    v_mfma_f32_16x16x32_bf16 v[48:51], v[184:187], v[104:107], 0
    v_cvt_pk_bf16_f32 v45, v30, v31
    v_cvt_pk_bf16_f32 v46, v34, v35
    v_mfma_f32_16x16x32_bf16 v[52:55], v[184:187], v[112:115], 0
    v_cvt_pk_bf16_f32 v47, v38, v39
    buffer_store_dwordx4 v[44:47], v8, s[36:39], s60 offen offset:1024 sc1
    v_mfma_f32_16x16x32_bf16 v[56:59], v[184:187], v[120:123], 0
    v_mfma_f32_16x16x32_bf16 v[60:63], v[184:187], v[128:131], 0
    s_mov_b64 exec, s[66:67]
    v_pk_mov_b32 v[108:109], 0, 0
    v_pk_mov_b32 v[110:111], 0, 0
    v_pk_mov_b32 v[116:117], 0, 0
    v_pk_mov_b32 v[118:119], 0, 0
    v_pk_mov_b32 v[124:125], 0, 0
    v_pk_mov_b32 v[126:127], 0, 0
    v_pk_mov_b32 v[132:133], 0, 0
    v_pk_mov_b32 v[134:135], 0, 0
    s_mov_b64 exec, -1
    v_mfma_f32_16x16x32_bf16 v[48:51], v[188:191], v[108:111], v[48:51]
    v_cvt_pk_bf16_f32 v88, v72, v73
    v_cvt_pk_bf16_f32 v89, v76, v77
    v_mfma_f32_16x16x32_bf16 v[52:55], v[188:191], v[116:119], v[52:55]
    v_cvt_pk_bf16_f32 v90, v80, v81
    v_cvt_pk_bf16_f32 v91, v84, v85
    v_mfma_f32_16x16x32_bf16 v[56:59], v[188:191], v[124:127], v[56:59]
    buffer_store_dwordx4 v[88:91], v9, s[36:39], s59 offen offset:0 sc1
    v_cvt_pk_bf16_f32 v92, v74, v75
    v_mfma_f32_16x16x32_bf16 v[60:63], v[188:191], v[132:135], v[60:63]
    v_cvt_pk_bf16_f32 v93, v78, v79
    v_cvt_pk_bf16_f32 v94, v82, v83
    v_cvt_pk_bf16_f32 v95, v86, v87
    buffer_store_dwordx4 v[92:95], v9, s[36:39], s60 offen offset:0 sc1
    v_cvt_pk_bf16_f32 v64, v48, v49
    v_cvt_pk_bf16_f32 v65, v52, v53
    v_cvt_pk_bf16_f32 v66, v56, v57
    s_nop 0
    v_cvt_pk_bf16_f32 v67, v60, v61
    buffer_store_dwordx4 v[64:67], v8, s[36:39], s59 offen offset:0 sc1
    v_cvt_pk_bf16_f32 v68, v50, v51
    v_cvt_pk_bf16_f32 v69, v54, v55
    v_cvt_pk_bf16_f32 v70, v58, v59
    v_cvt_pk_bf16_f32 v71, v62, v63
    buffer_store_dwordx4 v[68:71], v8, s[36:39], s60 offen offset:0 sc1
    s_waitcnt vmcnt(0)
    s_barrier
    s_barrier
    s_branch L_P2
L_QCOMP:
    s_lshl_b32 s56, s49, 1
    s_and_b32 s70, s50, 1
    s_add_u32 s56, s56, s70
    s_lshr_b32 s57, s50, 1
    s_mul_i32 s58, s57, 102
    s_mul_i32 s61, s51, 10
    s_add_u32 s61, s61, s57
    s_mul_i32 s61, s61, 44
    s_lshr_b32 s70, s56, 2
    s_and_b32 s71, s56, 1
    s_cmp_eq_u32 s70, s71
    s_cselect_b32 s61, 6000, s61
    v_add_u32 v4, s61, v0
    v_cmp_gt_u32 vcc, 5760, v4
    v_mul_u32_u24 v5, 7282, v4
    v_lshrrev_b32 v5, 16, v5
    v_mul_u32_u24 v6, 9, v5
    v_sub_u32 v4, v4, v6
    v_mul_u32_u24 v6, 11, v4
    v_lshrrev_b32 v6, 5, v6
    v_mul_u32_u24 v6, 896, v6
    v_lshl_add_u32 v4, v4, 7, v6
    v_and_b32 v6, 63, v5
    v_lshrrev_b32 v252, 7, v5
    v_add_u32 v252, s55, v252
    v_subrev_u32 v164, 5, v252
    v_min_u32 v252, v252, v164
    v_lshl_add_u32 v6, v252, 6, v6
    v_and_b32 v5, 64, v5
    v_mul_u32_u24 v5, 5, v5
    v_add_u32 v5, v5, v6
    v_mul_u32_u24 v5, 3840, v5
    v_add_u32 v4, v4, v5
    v_mov_b32 v5, 2147483648
    s_and_b32 vcc_lo, vcc_lo, 0xffffffff
    s_and_b32 vcc_hi, vcc_hi, 0xfff
    v_cndmask_b32_e64 v252, v5, v4, vcc
    s_mul_i32 s61, s49, 320
    s_and_b32 s61, s61, 0xffffff80
    s_waitcnt lgkmcnt(0)
    s_mov_b32 s32, s16
    s_mov_b32 s33, s17
    s_mov_b32 s34, 2457600
    s_mov_b32 s35, 0x20000
    buffer_load_dword v254, v252, s[32:35], s61 offen
    s_mov_b32 s40, s18
    s_mov_b32 s41, s19
    s_mov_b32 s42, 819200
    s_mov_b32 s43, 0x20000
    s_mov_b32 s36, s26
    s_mov_b32 s37, s27
    s_mov_b32 s38, 5505024
    s_mov_b32 s39, 0x20000
    s_mov_b32 s44, s24
    s_mov_b32 s45, s25
    s_mov_b32 s46, 256
    s_mov_b32 s47, 0x20000
    s_lshl_b32 s70, s51, 2
    v_lshrrev_b32 v4, 1, v0
    v_add_u32 v4, s70, v4
    s_cmp_eq_u32 s57, 9
    s_cselect_b32 s70, 10, 13
    v_cmp_gt_u32 s[72:73], s70, v4
    v_cmp_gt_u32 vcc, 7, v4
    v_add_u32 v4, s58, v4
    v_lshlrev_b32 v4, 1, v4
    v_add_u32 v4, s48, v4
    v_and_b32 v5, 31, v4
    v_lshlrev_b32 v5, 3, v5
    v_add_u32 v5, s56, v5
    v_lshrrev_b32 v4, 5, v4
    v_lshl_add_u32 v4, v5, 6, v4
    v_cndmask_b32_e64 v5, 0, 1, vcc
    v_cndmask_b32 v6, 6, 7, s[72:73]
    s_mov_b32 s72, 0xaaaaaaaa
    s_mov_b32 s73, s72
    v_cndmask_b32 v5, v5, v6, s[72:73]
    v_add_u32 v4, v4, v5
    v_mul_u32_u24 v4, 160, v4
    s_mov_b64 exec, 0x55
    buffer_load_dword v254, v4, s[36:39], 0 offen sc1
    s_mov_b64 exec, -1
    v_and_b32 v2, 15, v0
    v_lshrrev_b32 v3, 4, v0
    v_lshlrev_b32 v4, 2, v3
    v_sub_u32 v4, v2, v4
    v_mov_b32 v6, 0xff800000
    v_mov_b32 v20, 0
    v_mov_b32 v21, 0
    v_subrev_u32 v5, 0, v4
    v_cmp_gt_u32 vcc, 8, v5
    s_nop 1
    v_cndmask_b32_e64 v28, v6, v20, vcc
    v_cmp_gt_i32 vcc, -8, v5
    s_nop 1
    v_cndmask_b32_e64 v32, v6, v20, vcc
    v_mov_b32 v24, 0x3f803f80
    v_subrev_u32 v5, 1, v4
    v_cmp_gt_u32 vcc, 8, v5
    s_nop 1
    v_cndmask_b32_e64 v29, v6, v20, vcc
    v_cmp_gt_i32 vcc, -8, v5
    s_nop 1
    v_cndmask_b32_e64 v33, v6, v20, vcc
    v_mov_b32 v25, 0x3f803f80
    v_subrev_u32 v5, 2, v4
    v_cmp_gt_u32 vcc, 8, v5
    s_nop 1
    v_cndmask_b32_e64 v30, v6, v20, vcc
    v_cmp_gt_i32 vcc, -8, v5
    s_nop 1
    v_cndmask_b32_e64 v34, v6, v20, vcc
    v_mov_b32 v26, 0x3f803f80
    v_subrev_u32 v5, 3, v4
    v_cmp_gt_u32 vcc, 8, v5
    s_nop 1
    v_cndmask_b32_e64 v31, v6, v20, vcc
    v_cmp_gt_i32 vcc, -8, v5
    s_nop 1
    v_cndmask_b32_e64 v35, v6, v20, vcc
    v_mov_b32 v27, 0x3f803f80
    v_and_b32 v4, 0x33, v0
    v_mov_b32 v5, 0x3f80
    v_cmp_eq_u32 vcc, 48, v4
    s_nop 1
    v_cndmask_b32_e64 v22, 0, v5, vcc
    v_mov_b32 v5, 0x3f800000
    v_cmp_eq_u32 vcc, 49, v4
    s_nop 1
    v_cndmask_b32_e64 v22, v22, v5, vcc
    v_mov_b32 v5, 0x3f80
    v_cmp_eq_u32 vcc, 50, v4
    s_nop 1
    v_cndmask_b32_e64 v23, 0, v5, vcc
    v_mov_b32 v5, 0x3f800000
    v_cmp_eq_u32 vcc, 51, v4
    s_nop 1
    v_cndmask_b32_e64 v23, v23, v5, vcc
    v_pk_mov_b32 v[36:37], 0, 0
    s_mul_i32 s70, s51, 40
    s_add_u32 s70, s70, 141312
    v_mul_u32_u24 v6, 176, v2
    v_add_u32 v6, s70, v6
    v_lshl_add_u32 v7, v3, 3, v6
    v_mul_u32_u24 v8, 176, v0
    s_add_u32 s70, s70, 32
    v_add_u32 v8, s70, v8
    v_bfe_u32 v4, v2, 1, 3
    v_xor_b32 v4, v4, v3
    v_lshlrev_b32 v4, 4, v4
    v_lshl_add_u32 v4, v2, 7, v4
    v_add_u32 v12, 94208, v4
    v_xor_b32 v13, 64, v12
    s_and_b32 s65, s56, 3
    s_lshl_b32 s65, s65, 5
    s_sub_u32 s64, 128, s65
    s_add_u32 s65, s65, 32
    s_mul_i32 s66, s64, 24
    v_bfe_u32 v164, v0, 2, 3
    v_mov_b32 v165, s64
    v_mov_b32 v170, s65
    v_mov_b32 v171, s66
    v_lshrrev_b32 v166, 5, v0
    v_lshlrev_b32 v166, 13, v166
    v_add_u32 v166, 108544, v166
    s_mul_i32 s61, s51, 40
    v_and_b32 v168, 3, v0
    v_lshl_add_u32 v167, v168, 3, s61
    v_cmp_gt_u32 vcc, s64, v167
    v_subrev_u32 v4, s64, v167
    v_min_u32 v4, v4, v167
    v_cndmask_b32_e64 v16, v170, v165, vcc
    v_mul_u32_u24 v5, v16, v164
    v_and_b32 v6, 32, v16
    v_sub_u32 v6, 32, v6
    v_lshrrev_b32 v14, 8, v5
    v_mul_u32_u24 v6, v6, v14
    v_xor_b32 v4, v4, v6
    v_cndmask_b32_e64 v6, v171, 0, vcc
    v_add3_u32 v14, v4, v5, v6
    v_add_u32 v14, v14, v166
    v_lshl_add_u32 v15, v16, 3, v14
    v_lshl_add_u32 v16, v16, 4, v14
    s_add_u32 s61, s61, 32
    v_mov_b32 v167, s61
    v_cmp_gt_u32 vcc, s64, v167
    v_subrev_u32 v4, s64, v167
    v_min_u32 v4, v4, v167
    v_cndmask_b32_e64 v169, v170, v165, vcc
    v_mul_u32_u24 v5, v169, v164
    v_and_b32 v6, 32, v169
    v_sub_u32 v6, 32, v6
    v_lshrrev_b32 v17, 8, v5
    v_mul_u32_u24 v6, v6, v17
    v_xor_b32 v4, v4, v6
    v_cndmask_b32_e64 v6, v171, 0, vcc
    v_add3_u32 v17, v4, v5, v6
    v_add_u32 v17, v17, v166
    v_min_u32 v4, 2, v168
    v_mul_u32_u24 v4, v4, v169
    v_lshl_add_u32 v17, v4, 3, v17
    v_add_u32 v4, 3840, v166
    v_cmp_eq_u32 vcc, 2, v168
    s_nop 1
    v_cndmask_b32_e64 v17, v17, v4, vcc
    s_mov_b32 s59, 94208
    s_cmp_eq_u32 s57, 0
    s_cselect_b32 s73, 0, 7
    s_cmp_eq_u32 s57, 9
    s_cselect_b32 s63, 10, 13
    v_mul_u32_u24 v19, 26, v0
    v_lshrrev_b32 v19, 8, v19
    s_lshl_b32 s71, s51, 2
    v_add_u32 v4, s71, v19
    v_mul_u32_u24 v5, 10, v19
    v_sub_u32 v5, v0, v5
    v_mul_u32_u24 v252, 176, v4
    v_lshl_add_u32 v252, v5, 4, v252
    v_cmp_gt_u32 s[82:83], s63, v4
    v_cmp_le_u32 s[80:81], s73, v4
    v_add_u32 v4, s58, v4
    v_lshlrev_b32 v4, 1, v4
    v_add_u32 v4, s48, v4
    v_and_b32 v253, 31, v4
    v_lshlrev_b32 v253, 3, v253
    v_add_u32 v253, s56, v253
    v_lshrrev_b32 v4, 5, v4
    v_and_b32 v6, 1, v4
    v_cmp_eq_u32 vcc, 1, v6
    v_xor_b32 v6, 1, v6
    v_mul_u32_u24 v6, 6, v6
    v_add_u32 v4, v4, v6
    v_mul_u32_u24 v6, 2816, v6
    s_mov_b32 s71, 141312
    v_add3_u32 v252, v252, v6, s71
    v_lshl_add_u32 v4, v253, 6, v4
    v_mul_u32_u24 v4, 160, v4
    v_lshl_add_u32 v4, v5, 4, v4
    s_and_b64 s[80:81], s[80:81], vcc
    s_andn2_b64 s[82:83], s[82:83], vcc
    s_or_b64 s[82:83], s[82:83], s[80:81]
    s_and_b32 s83, s83, 0xff
    v_mov_b32 v5, 2147483648
    v_cndmask_b32 v253, v5, v4, s[82:83]
    v_mov_b32 v5, 141312
    v_cndmask_b32 v252, v5, v252, s[82:83]
    v_min_u32 v19, 5, v19
    v_mul_u32_u24 v18, 2656, v19
    v_lshl_add_u32 v18, v0, 4, v18
    v_lshlrev_b32 v19, 4, v0
    s_lshl_b32 s70, s51, 2
    s_add_u32 s70, s70, 0
    s_add_u32 s71, s70, s58
    s_lshl_b32 s71, s71, 1
    s_add_u32 s71, s71, s48
    s_and_b32 s72, s71, 31
    s_lshl_b32 s72, s72, 3
    s_add_u32 s72, s72, s56
    s_lshl_b32 s72, s72, 6
    s_lshr_b32 s71, s71, 5
    s_add_u32 s71, s71, s72
    s_and_b32 s72, s71, 1
    s_add_u32 s71, s71, s72
    s_mul_i32 s74, s71, 160
    s_mul_i32 s71, s72, 16
    s_add_u32 s71, s71, s70
    s_mul_i32 s78, s71, 176
    s_add_u32 s78, s78, 141312
    s_cmp_ge_u32 s71, s73
    s_cselect_b32 s28, -1, 0xfffffc00
    s_add_u32 s72, s63, 16
    s_cmp_lt_u32 s71, s72
    s_mov_b32 s71, 0x0fffffff
    s_cselect_b32 s29, s71, 0x3ffff
    s_lshl_b32 s70, s51, 2
    s_add_u32 s70, s70, 1
    s_add_u32 s71, s70, s58
    s_lshl_b32 s71, s71, 1
    s_add_u32 s71, s71, s48
    s_and_b32 s72, s71, 31
    s_lshl_b32 s72, s72, 3
    s_add_u32 s72, s72, s56
    s_lshl_b32 s72, s72, 6
    s_lshr_b32 s71, s71, 5
    s_add_u32 s71, s71, s72
    s_and_b32 s72, s71, 1
    s_add_u32 s71, s71, s72
    s_mul_i32 s75, s71, 160
    s_mul_i32 s71, s72, 16
    s_add_u32 s71, s71, s70
    s_mul_i32 s79, s71, 176
    s_add_u32 s79, s79, 141312
    s_cmp_ge_u32 s71, s73
    s_cselect_b32 s30, -1, 0xfffffc00
    s_add_u32 s72, s63, 16
    s_cmp_lt_u32 s71, s72
    s_mov_b32 s71, 0x0fffffff
    s_cselect_b32 s31, s71, 0x3ffff
    s_lshl_b32 s70, s51, 2
    s_add_u32 s70, s70, 2
    s_add_u32 s71, s70, s58
    s_lshl_b32 s71, s71, 1
    s_add_u32 s71, s71, s48
    s_and_b32 s72, s71, 31
    s_lshl_b32 s72, s72, 3
    s_add_u32 s72, s72, s56
    s_lshl_b32 s72, s72, 6
    s_lshr_b32 s71, s71, 5
    s_add_u32 s71, s71, s72
    s_and_b32 s72, s71, 1
    s_add_u32 s71, s71, s72
    s_mul_i32 s76, s71, 160
    s_mul_i32 s71, s72, 16
    s_add_u32 s71, s71, s70
    s_mul_i32 s80, s71, 176
    s_add_u32 s80, s80, 141312
    s_cmp_ge_u32 s71, s73
    s_cselect_b32 s32, -1, 0xfffffc00
    s_add_u32 s72, s63, 16
    s_cmp_lt_u32 s71, s72
    s_mov_b32 s71, 0x0fffffff
    s_cselect_b32 s33, s71, 0x3ffff
    s_lshl_b32 s70, s51, 2
    s_add_u32 s70, s70, 3
    s_add_u32 s71, s70, s58
    s_lshl_b32 s71, s71, 1
    s_add_u32 s71, s71, s48
    s_and_b32 s72, s71, 31
    s_lshl_b32 s72, s72, 3
    s_add_u32 s72, s72, s56
    s_lshl_b32 s72, s72, 6
    s_lshr_b32 s71, s71, 5
    s_add_u32 s71, s71, s72
    s_and_b32 s72, s71, 1
    s_add_u32 s71, s71, s72
    s_mul_i32 s77, s71, 160
    s_mul_i32 s71, s72, 16
    s_add_u32 s71, s71, s70
    s_mul_i32 s81, s71, 176
    s_add_u32 s81, s81, 141312
    s_cmp_ge_u32 s71, s73
    s_cselect_b32 s34, -1, 0xfffffc00
    s_add_u32 s72, s63, 16
    s_cmp_lt_u32 s71, s72
    s_mov_b32 s71, 0x0fffffff
    s_cselect_b32 s35, s71, 0x3ffff
    s_waitcnt lgkmcnt(0)
    s_mov_b32 s67, -94208
    s_mov_b32 s68, 47104
    s_mov_b32 s60, 0
    s_barrier
    ds_read_b64_tr_b16 v[192:193], v14 offset:0
    ds_read_b64_tr_b16 v[194:195], v14 offset:4096
    ds_read_b64_tr_b16 v[196:197], v15 offset:0
    ds_read_b64_tr_b16 v[198:199], v15 offset:4096
    ds_read_b64_tr_b16 v[200:201], v17 offset:0
    ds_read_b64_tr_b16 v[202:203], v17 offset:4096
    ds_read_b64_tr_b16 v[204:205], v16 offset:0
    ds_read_b64_tr_b16 v[206:207], v16 offset:4096
    ds_read_b128 v[164:167], v12 offset:0
    ds_read_b128 v[168:171], v12 offset:2048
    ds_read_b128 v[172:175], v12 offset:4096
    ds_read_b128 v[176:179], v12 offset:6144
    ds_read_b128 v[180:183], v12 offset:8192
    ds_read_b128 v[184:187], v12 offset:10240
    ds_read_b128 v[188:191], v12 offset:12288
    s_waitcnt lgkmcnt(0)
    v_mfma_f32_16x16x32_bf16 v[52:55], v[192:195], v[164:167], 0
    v_mfma_f32_16x16x32_bf16 v[68:71], v[192:195], v[168:171], 0
    v_mfma_f32_16x16x32_bf16 v[84:87], v[192:195], v[172:175], 0
    v_mfma_f32_16x16x32_bf16 v[100:103], v[192:195], v[176:179], 0
    v_mfma_f32_16x16x32_bf16 v[116:119], v[192:195], v[180:183], 0
    v_mfma_f32_16x16x32_bf16 v[132:135], v[192:195], v[184:187], 0
    v_mfma_f32_16x16x32_bf16 v[148:151], v[192:195], v[188:191], 0
    v_mfma_f32_16x16x32_bf16 v[152:155], v[196:199], v[188:191], 0
    v_mfma_f32_16x16x32_bf16 v[136:139], v[196:199], v[184:187], 0
    v_mfma_f32_16x16x32_bf16 v[120:123], v[196:199], v[180:183], 0
    v_mfma_f32_16x16x32_bf16 v[104:107], v[196:199], v[176:179], 0
    v_mfma_f32_16x16x32_bf16 v[88:91], v[196:199], v[172:175], 0
    v_mfma_f32_16x16x32_bf16 v[72:75], v[196:199], v[168:171], 0
    v_mfma_f32_16x16x32_bf16 v[56:59], v[196:199], v[164:167], 0
    v_mfma_f32_16x16x32_bf16 v[60:63], v[200:203], v[164:167], 0
    v_mfma_f32_16x16x32_bf16 v[76:79], v[200:203], v[168:171], 0
    s_barrier
    v_mfma_f32_16x16x32_bf16 v[92:95], v[200:203], v[172:175], 0
    ds_read_b64_tr_b16 v[236:237], v14 offset:16384
    ds_read_b64_tr_b16 v[238:239], v14 offset:20480
    v_mfma_f32_16x16x32_bf16 v[108:111], v[200:203], v[176:179], 0
    ds_read_b64_tr_b16 v[240:241], v15 offset:16384
    ds_read_b64_tr_b16 v[242:243], v15 offset:20480
    v_mfma_f32_16x16x32_bf16 v[124:127], v[200:203], v[180:183], 0
    ds_read_b64_tr_b16 v[244:245], v17 offset:16384
    ds_read_b64_tr_b16 v[246:247], v17 offset:20480
    v_mfma_f32_16x16x32_bf16 v[140:143], v[200:203], v[184:187], 0
    ds_read_b64_tr_b16 v[248:249], v16 offset:16384
    ds_read_b64_tr_b16 v[250:251], v16 offset:20480
    v_mfma_f32_16x16x32_bf16 v[156:159], v[200:203], v[188:191], 0
    ds_read_b128 v[208:211], v13 offset:0
    ds_read_b128 v[212:215], v13 offset:2048
    v_mfma_f32_16x16x32_bf16 v[160:163], v[188:191], v[204:207], 0
    ds_read_b128 v[216:219], v13 offset:4096
    ds_read_b128 v[220:223], v13 offset:6144
    v_mfma_f32_16x16x32_bf16 v[144:147], v[184:187], v[204:207], 0
    ds_read_b128 v[224:227], v13 offset:8192
    ds_read_b128 v[228:231], v13 offset:10240
    v_mfma_f32_16x16x32_bf16 v[128:131], v[180:183], v[204:207], 0
    ds_read_b128 v[232:235], v13 offset:12288
    s_cmp_eq_u32 s59, 94208
    s_cselect_b32 s62, s67, s68
    s_add_u32 s59, s59, s62
    v_mfma_f32_16x16x32_bf16 v[112:115], v[176:179], v[204:207], 0
    v_add_u32 v12, s62, v12
    v_add_u32 v13, s62, v13
    v_add_u32 v14, s62, v14
    v_add_u32 v15, s62, v15
    v_mfma_f32_16x16x32_bf16 v[96:99], v[172:175], v[204:207], 0
    v_add_u32 v16, s62, v16
    v_add_u32 v17, s62, v17
    s_add_u32 s60, s60, 1
    s_nop 0
    v_mfma_f32_16x16x32_bf16 v[80:83], v[168:171], v[204:207], 0
    v_mfma_f32_16x16x32_bf16 v[64:67], v[164:167], v[204:207], 0
    s_branch Q_MID
.p2align 3
Q_LOOP:
    v_mfma_f32_16x16x32_bf16 v[52:55], v[192:195], v[164:167], v[52:55]
    ds_read_b64_tr_b16 v[236:237], v14 offset:16384
    v_mfma_f32_16x16x32_bf16 v[68:71], v[192:195], v[168:171], v[68:71]
    ds_read_b64_tr_b16 v[238:239], v14 offset:20480
    v_mfma_f32_16x16x32_bf16 v[84:87], v[192:195], v[172:175], v[84:87]
    ds_read_b64_tr_b16 v[240:241], v15 offset:16384
    v_mfma_f32_16x16x32_bf16 v[100:103], v[192:195], v[176:179], v[100:103]
    ds_read_b64_tr_b16 v[242:243], v15 offset:20480
    v_mfma_f32_16x16x32_bf16 v[116:119], v[192:195], v[180:183], v[116:119]
    ds_read_b64_tr_b16 v[244:245], v17 offset:16384
    v_mfma_f32_16x16x32_bf16 v[132:135], v[192:195], v[184:187], v[132:135]
    ds_read_b64_tr_b16 v[246:247], v17 offset:20480
    v_mfma_f32_16x16x32_bf16 v[148:151], v[192:195], v[188:191], v[148:151]
    ds_read_b64_tr_b16 v[248:249], v16 offset:16384
    v_mfma_f32_16x16x32_bf16 v[152:155], v[196:199], v[188:191], v[152:155]
    ds_read_b64_tr_b16 v[250:251], v16 offset:20480
    v_mfma_f32_16x16x32_bf16 v[136:139], v[196:199], v[184:187], v[136:139]
    ds_read_b128 v[208:211], v13 offset:0
    v_mfma_f32_16x16x32_bf16 v[120:123], v[196:199], v[180:183], v[120:123]
    ds_read_b128 v[212:215], v13 offset:2048
    v_mfma_f32_16x16x32_bf16 v[104:107], v[196:199], v[176:179], v[104:107]
    ds_read_b128 v[216:219], v13 offset:4096
    v_mfma_f32_16x16x32_bf16 v[88:91], v[196:199], v[172:175], v[88:91]
    ds_read_b128 v[220:223], v13 offset:6144
    v_mfma_f32_16x16x32_bf16 v[72:75], v[196:199], v[168:171], v[72:75]
    ds_read_b128 v[224:227], v13 offset:8192
    v_mfma_f32_16x16x32_bf16 v[56:59], v[196:199], v[164:167], v[56:59]
    ds_read_b128 v[228:231], v13 offset:10240
    v_mfma_f32_16x16x32_bf16 v[60:63], v[200:203], v[164:167], v[60:63]
    ds_read_b128 v[232:235], v13 offset:12288
    v_mfma_f32_16x16x32_bf16 v[76:79], v[200:203], v[168:171], v[76:79]
    s_cmp_eq_u32 s59, 94208
    s_cselect_b32 s62, s67, s68
    s_add_u32 s59, s59, s62
    v_mfma_f32_16x16x32_bf16 v[92:95], v[200:203], v[172:175], v[92:95]
    v_add_u32 v12, s62, v12
    v_add_u32 v13, s62, v13
    v_mfma_f32_16x16x32_bf16 v[108:111], v[200:203], v[176:179], v[108:111]
    v_add_u32 v14, s62, v14
    v_add_u32 v15, s62, v15
    v_mfma_f32_16x16x32_bf16 v[124:127], v[200:203], v[180:183], v[124:127]
    v_add_u32 v16, s62, v16
    v_add_u32 v17, s62, v17
    v_mfma_f32_16x16x32_bf16 v[140:143], v[200:203], v[184:187], v[140:143]
    s_add_u32 s60, s60, 1
    s_nop 0
    v_mfma_f32_16x16x32_bf16 v[156:159], v[200:203], v[188:191], v[156:159]
    v_mfma_f32_16x16x32_bf16 v[160:163], v[188:191], v[204:207], v[160:163]
    v_mfma_f32_16x16x32_bf16 v[144:147], v[184:187], v[204:207], v[144:147]
    v_mfma_f32_16x16x32_bf16 v[128:131], v[180:183], v[204:207], v[128:131]
    v_mfma_f32_16x16x32_bf16 v[112:115], v[176:179], v[204:207], v[112:115]
    v_mfma_f32_16x16x32_bf16 v[96:99], v[172:175], v[204:207], v[96:99]
    v_mfma_f32_16x16x32_bf16 v[80:83], v[168:171], v[204:207], v[80:83]
    v_mfma_f32_16x16x32_bf16 v[64:67], v[164:167], v[204:207], v[64:67]
Q_MID:
    s_waitcnt lgkmcnt(0)
    s_barrier
    v_mfma_f32_16x16x32_bf16 v[52:55], v[236:239], v[208:211], v[52:55]
    ds_read_b64_tr_b16 v[192:193], v14 offset:0
    v_mfma_f32_16x16x32_bf16 v[68:71], v[236:239], v[212:215], v[68:71]
    ds_read_b64_tr_b16 v[194:195], v14 offset:4096
    v_mfma_f32_16x16x32_bf16 v[84:87], v[236:239], v[216:219], v[84:87]
    ds_read_b64_tr_b16 v[196:197], v15 offset:0
    v_mfma_f32_16x16x32_bf16 v[100:103], v[236:239], v[220:223], v[100:103]
    ds_read_b64_tr_b16 v[198:199], v15 offset:4096
    v_mfma_f32_16x16x32_bf16 v[116:119], v[236:239], v[224:227], v[116:119]
    ds_read_b64_tr_b16 v[200:201], v17 offset:0
    v_mfma_f32_16x16x32_bf16 v[132:135], v[236:239], v[228:231], v[132:135]
    ds_read_b64_tr_b16 v[202:203], v17 offset:4096
    v_mfma_f32_16x16x32_bf16 v[148:151], v[236:239], v[232:235], v[148:151]
    ds_read_b64_tr_b16 v[204:205], v16 offset:0
    v_mfma_f32_16x16x32_bf16 v[152:155], v[240:243], v[232:235], v[152:155]
    ds_read_b64_tr_b16 v[206:207], v16 offset:4096
    v_mfma_f32_16x16x32_bf16 v[136:139], v[240:243], v[228:231], v[136:139]
    ds_read_b128 v[164:167], v12 offset:0
    v_mfma_f32_16x16x32_bf16 v[120:123], v[240:243], v[224:227], v[120:123]
    ds_read_b128 v[168:171], v12 offset:2048
    v_mfma_f32_16x16x32_bf16 v[104:107], v[240:243], v[220:223], v[104:107]
    ds_read_b128 v[172:175], v12 offset:4096
    v_mfma_f32_16x16x32_bf16 v[88:91], v[240:243], v[216:219], v[88:91]
    ds_read_b128 v[176:179], v12 offset:6144
    v_mfma_f32_16x16x32_bf16 v[72:75], v[240:243], v[212:215], v[72:75]
    ds_read_b128 v[180:183], v12 offset:8192
    v_mfma_f32_16x16x32_bf16 v[56:59], v[240:243], v[208:211], v[56:59]
    ds_read_b128 v[184:187], v12 offset:10240
    v_mfma_f32_16x16x32_bf16 v[60:63], v[244:247], v[208:211], v[60:63]
    ds_read_b128 v[188:191], v12 offset:12288
    v_mfma_f32_16x16x32_bf16 v[76:79], v[244:247], v[212:215], v[76:79]
    s_cmp_lg_u32 s60, 9
    s_nop 0
    v_mfma_f32_16x16x32_bf16 v[92:95], v[244:247], v[216:219], v[92:95]
    v_mfma_f32_16x16x32_bf16 v[108:111], v[244:247], v[220:223], v[108:111]
    v_mfma_f32_16x16x32_bf16 v[124:127], v[244:247], v[224:227], v[124:127]
    v_mfma_f32_16x16x32_bf16 v[140:143], v[244:247], v[228:231], v[140:143]
    v_mfma_f32_16x16x32_bf16 v[156:159], v[244:247], v[232:235], v[156:159]
    v_mfma_f32_16x16x32_bf16 v[160:163], v[232:235], v[248:251], v[160:163]
    v_mfma_f32_16x16x32_bf16 v[144:147], v[228:231], v[248:251], v[144:147]
    v_mfma_f32_16x16x32_bf16 v[128:131], v[224:227], v[248:251], v[128:131]
    v_mfma_f32_16x16x32_bf16 v[112:115], v[220:223], v[248:251], v[112:115]
    v_mfma_f32_16x16x32_bf16 v[96:99], v[216:219], v[248:251], v[96:99]
    v_mfma_f32_16x16x32_bf16 v[80:83], v[212:215], v[248:251], v[80:83]
    v_mfma_f32_16x16x32_bf16 v[64:67], v[208:211], v[248:251], v[64:67]
    s_waitcnt lgkmcnt(0)
    s_cbranch_scc1 Q_LOOP
    s_barrier
    s_waitcnt vmcnt(0)
    v_mfma_f32_16x16x32_bf16 v[52:55], v[192:195], v[164:167], v[52:55]
    ds_read_b64_tr_b16 v[236:237], v14 offset:16384
    v_mfma_f32_16x16x32_bf16 v[56:59], v[196:199], v[164:167], v[56:59]
    ds_read_b64_tr_b16 v[238:239], v14 offset:20480
    v_mfma_f32_16x16x32_bf16 v[60:63], v[200:203], v[164:167], v[60:63]
    ds_read_b64_tr_b16 v[240:241], v15 offset:16384
    v_mfma_f32_16x16x32_bf16 v[64:67], v[164:167], v[204:207], v[64:67]
    ds_read_b64_tr_b16 v[242:243], v15 offset:20480
    v_mfma_f32_16x16x32_bf16 v[68:71], v[192:195], v[168:171], v[68:71]
    ds_read_b64_tr_b16 v[244:245], v17 offset:16384
    v_mfma_f32_16x16x32_bf16 v[72:75], v[196:199], v[168:171], v[72:75]
    ds_read_b64_tr_b16 v[246:247], v17 offset:20480
    v_mfma_f32_16x16x32_bf16 v[76:79], v[200:203], v[168:171], v[76:79]
    ds_read_b64_tr_b16 v[248:249], v16 offset:16384
    v_mfma_f32_16x16x32_bf16 v[80:83], v[168:171], v[204:207], v[80:83]
    ds_read_b64_tr_b16 v[250:251], v16 offset:20480
    v_mfma_f32_16x16x32_bf16 v[84:87], v[192:195], v[172:175], v[84:87]
    ds_read_b128 v[208:211], v13 offset:0
    v_mfma_f32_16x16x32_bf16 v[88:91], v[196:199], v[172:175], v[88:91]
    ds_read_b128 v[212:215], v13 offset:2048
    v_mfma_f32_16x16x32_bf16 v[92:95], v[200:203], v[172:175], v[92:95]
    ds_read_b128 v[216:219], v13 offset:4096
    v_mfma_f32_16x16x32_bf16 v[96:99], v[172:175], v[204:207], v[96:99]
    ds_read_b128 v[220:223], v13 offset:6144
    v_mfma_f32_16x16x32_bf16 v[100:103], v[192:195], v[176:179], v[100:103]
    ds_read_b128 v[224:227], v13 offset:8192
    v_mfma_f32_16x16x32_bf16 v[104:107], v[196:199], v[176:179], v[104:107]
    ds_read_b128 v[228:231], v13 offset:10240
    v_mfma_f32_16x16x32_bf16 v[108:111], v[200:203], v[176:179], v[108:111]
    ds_read_b128 v[232:235], v13 offset:12288
    v_mfma_f32_16x16x32_bf16 v[112:115], v[176:179], v[204:207], v[112:115]
    v_mfma_f32_16x16x32_bf16 v[116:119], v[192:195], v[180:183], v[116:119]
    v_mfma_f32_16x16x32_bf16 v[120:123], v[196:199], v[180:183], v[120:123]
    v_mfma_f32_16x16x32_bf16 v[124:127], v[200:203], v[180:183], v[124:127]
    v_mfma_f32_16x16x32_bf16 v[128:131], v[180:183], v[204:207], v[128:131]
    s_waitcnt lgkmcnt(0)
    s_barrier
    v_mfma_f32_16x16x32_bf16 v[52:55], v[236:239], v[208:211], v[52:55]
    v_pk_mov_b32 v[164:165], 0, 0
    v_mfma_f32_16x16x32_bf16 v[56:59], v[240:243], v[208:211], v[56:59]
    v_pk_mov_b32 v[168:169], 0, 0
    v_mfma_f32_16x16x32_bf16 v[60:63], v[244:247], v[208:211], v[60:63]
    v_pk_mov_b32 v[172:173], 0, 0
    v_mfma_f32_16x16x32_bf16 v[64:67], v[208:211], v[248:251], v[64:67]
    v_pk_mov_b32 v[176:177], 0, 0
    v_mfma_f32_16x16x32_bf16 v[68:71], v[236:239], v[212:215], v[68:71]
    v_pk_mov_b32 v[180:181], 0, 0
    v_mfma_f32_16x16x32_bf16 v[72:75], v[240:243], v[212:215], v[72:75]
    v_add_u32 v10, s78, v18
    v_add_u32 v11, s79, v18
    v_mfma_f32_16x16x32_bf16 v[76:79], v[244:247], v[212:215], v[76:79]
    v_add_u32 v12, s80, v18
    v_add_u32 v13, s81, v18
    v_mfma_f32_16x16x32_bf16 v[80:83], v[212:215], v[248:251], v[80:83]
    s_mov_b32 s70, 0x3ea52b5c
    s_mov_b32 s71, s70
    s_mov_b32 s72, 0
    s_mov_b32 s73, 0x00ff00ff
    v_mfma_f32_16x16x32_bf16 v[84:87], v[236:239], v[216:219], v[84:87]
    v_cvt_pk_bf16_f32 v56, v56, v57
    v_cvt_pk_bf16_f32 v57, v58, v59
    v_mfma_f32_16x16x32_bf16 v[88:91], v[240:243], v[216:219], v[88:91]
    v_cvt_pk_bf16_f32 v52, v52, v53
    v_cvt_pk_bf16_f32 v53, v54, v55
    v_mfma_f32_16x16x32_bf16 v[92:95], v[244:247], v[216:219], v[92:95]
    v_cvt_pk_bf16_f32 v58, v60, v61
    v_cvt_pk_bf16_f32 v59, v62, v63
    v_mfma_f32_16x16x32_bf16 v[96:99], v[216:219], v[248:251], v[96:99]
    v_cvt_pk_bf16_f32 v38, v64, v65
    v_cvt_pk_bf16_f32 v39, v66, v67
    v_mfma_f32_16x16x32_bf16 v[100:103], v[236:239], v[220:223], v[100:103]
    v_pk_mov_b32 v[54:55], 0, 0
    v_cvt_pk_bf16_f32 v72, v72, v73
    v_mfma_f32_16x16x32_bf16 v[104:107], v[240:243], v[220:223], v[104:107]
    v_cvt_pk_bf16_f32 v73, v74, v75
    v_cvt_pk_bf16_f32 v68, v68, v69
    v_mfma_f32_16x16x32_bf16 v[108:111], v[244:247], v[220:223], v[108:111]
    v_cvt_pk_bf16_f32 v69, v70, v71
    v_cvt_pk_bf16_f32 v74, v76, v77
    v_mfma_f32_16x16x32_bf16 v[112:115], v[220:223], v[248:251], v[112:115]
    v_cvt_pk_bf16_f32 v75, v78, v79
    v_cvt_pk_bf16_f32 v40, v80, v81
    v_mfma_f32_16x16x32_bf16 v[116:119], v[236:239], v[224:227], v[116:119]
    v_cvt_pk_bf16_f32 v41, v82, v83
    v_pk_mov_b32 v[70:71], 0, 0
    v_mfma_f32_16x16x32_bf16 v[120:123], v[240:243], v[224:227], v[120:123]
    v_cvt_pk_bf16_f32 v88, v88, v89
    v_cvt_pk_bf16_f32 v89, v90, v91
    v_mfma_f32_16x16x32_bf16 v[124:127], v[244:247], v[224:227], v[124:127]
    v_cvt_pk_bf16_f32 v84, v84, v85
    v_cvt_pk_bf16_f32 v85, v86, v87
    v_mfma_f32_16x16x32_bf16 v[128:131], v[224:227], v[248:251], v[128:131]
    v_cvt_pk_bf16_f32 v90, v92, v93
    v_cvt_pk_bf16_f32 v91, v94, v95
    v_mfma_f32_16x16x32_bf16 v[132:135], v[192:195], v[184:187], v[132:135]
    v_cvt_pk_bf16_f32 v42, v96, v97
    v_cvt_pk_bf16_f32 v43, v98, v99
    v_mfma_f32_16x16x32_bf16 v[136:139], v[196:199], v[184:187], v[136:139]
    v_pk_mov_b32 v[86:87], 0, 0
    v_cvt_pk_bf16_f32 v104, v104, v105
    v_mfma_f32_16x16x32_bf16 v[140:143], v[200:203], v[184:187], v[140:143]
    v_cvt_pk_bf16_f32 v105, v106, v107
    v_cvt_pk_bf16_f32 v100, v100, v101
    v_mfma_f32_16x16x32_bf16 v[144:147], v[184:187], v[204:207], v[144:147]
    v_cvt_pk_bf16_f32 v101, v102, v103
    v_cvt_pk_bf16_f32 v106, v108, v109
    v_mfma_f32_16x16x32_bf16 v[132:135], v[236:239], v[228:231], v[132:135]
    v_cvt_pk_bf16_f32 v107, v110, v111
    v_cvt_pk_bf16_f32 v44, v112, v113
    v_mfma_f32_16x16x32_bf16 v[136:139], v[240:243], v[228:231], v[136:139]
    v_cvt_pk_bf16_f32 v45, v114, v115
    v_pk_mov_b32 v[102:103], 0, 0
    v_mfma_f32_16x16x32_bf16 v[140:143], v[244:247], v[228:231], v[140:143]
    v_cvt_pk_bf16_f32 v120, v120, v121
    v_cvt_pk_bf16_f32 v121, v122, v123
    v_mfma_f32_16x16x32_bf16 v[144:147], v[228:231], v[248:251], v[144:147]
    v_cvt_pk_bf16_f32 v116, v116, v117
    v_cvt_pk_bf16_f32 v117, v118, v119
    v_mfma_f32_16x16x32_bf16 v[148:151], v[192:195], v[188:191], v[148:151]
    v_cvt_pk_bf16_f32 v122, v124, v125
    v_cvt_pk_bf16_f32 v123, v126, v127
    v_mfma_f32_16x16x32_bf16 v[152:155], v[196:199], v[188:191], v[152:155]
    v_cvt_pk_bf16_f32 v46, v128, v129
    v_cvt_pk_bf16_f32 v47, v130, v131
    v_mfma_f32_16x16x32_bf16 v[156:159], v[200:203], v[188:191], v[156:159]
    v_pk_mov_b32 v[118:119], 0, 0
    v_mfma_f32_16x16x32_bf16 v[64:67], v[56:59], v[20:23], 0
    v_mfma_f32_16x16x32_bf16 v[160:163], v[188:191], v[204:207], v[160:163]
    v_mfma_f32_16x16x32_bf16 v[80:83], v[72:75], v[20:23], 0
    v_mfma_f32_16x16x32_bf16 v[148:151], v[236:239], v[232:235], v[148:151]
    v_permlane16_swap_b32 v54, v58
    v_mfma_f32_16x16x32_bf16 v[96:99], v[88:91], v[20:23], 0
    v_permlane16_swap_b32 v55, v59
    v_mfma_f32_16x16x32_bf16 v[152:155], v[240:243], v[232:235], v[152:155]
    v_permlane16_swap_b32 v70, v74
    v_mfma_f32_16x16x32_bf16 v[112:115], v[104:107], v[20:23], 0
    v_permlane16_swap_b32 v71, v75
    v_mfma_f32_16x16x32_bf16 v[156:159], v[244:247], v[232:235], v[156:159]
    v_permlane16_swap_b32 v86, v90
    v_mfma_f32_16x16x32_bf16 v[128:131], v[120:123], v[20:23], 0
    v_permlane16_swap_b32 v87, v91
    v_mfma_f32_16x16x32_bf16 v[160:163], v[232:235], v[248:251], v[160:163]
    v_mfma_f32_16x16x32_bf16 v[208:211], v[56:59], v[52:55], v[28:31]
    v_cvt_pk_bf16_f32 v136, v136, v137
    v_cvt_pk_bf16_f32 v137, v138, v139
    v_mfma_f32_16x16x32_bf16 v[212:215], v[72:75], v[68:71], v[28:31]
    v_cvt_pk_bf16_f32 v132, v132, v133
    v_cvt_pk_bf16_f32 v133, v134, v135
    v_mfma_f32_16x16x32_bf16 v[76:79], v[56:59], v[68:71], v[32:35]
    v_cvt_pk_bf16_f32 v138, v140, v141
    v_cvt_pk_bf16_f32 v139, v142, v143
    v_mfma_f32_16x16x32_bf16 v[216:219], v[88:91], v[84:87], v[28:31]
    v_cvt_pk_bf16_f32 v48, v144, v145
    v_cvt_pk_bf16_f32 v49, v146, v147
    v_mfma_f32_16x16x32_bf16 v[92:95], v[72:75], v[84:87], v[32:35]
    v_pk_mov_b32 v[134:135], 0, 0
    v_pk_mov_b32 v[184:185], 0, 0
    v_permlane16_swap_b32 v102, v106
    v_permlane16_swap_b32 v103, v107
    v_permlane16_swap_b32 v118, v122
    v_permlane16_swap_b32 v119, v123
    v_mfma_f32_16x16x32_bf16 v[144:147], v[136:139], v[20:23], 0
    v_cvt_pk_bf16_f32 v152, v152, v153
    v_cvt_pk_bf16_f32 v153, v154, v155
    v_mfma_f32_16x16x32_bf16 v[220:223], v[104:107], v[100:103], v[28:31]
    v_cvt_pk_bf16_f32 v148, v148, v149
    v_cvt_pk_bf16_f32 v149, v150, v151
    v_mfma_f32_16x16x32_bf16 v[108:111], v[88:91], v[100:103], v[32:35]
    v_cvt_pk_bf16_f32 v154, v156, v157
    v_cvt_pk_bf16_f32 v155, v158, v159
    v_mfma_f32_16x16x32_bf16 v[224:227], v[120:123], v[116:119], v[28:31]
    v_cvt_pk_bf16_f32 v50, v160, v161
    v_cvt_pk_bf16_f32 v51, v162, v163
    v_mfma_f32_16x16x32_bf16 v[124:127], v[104:107], v[116:119], v[32:35]
    v_pk_mov_b32 v[150:151], 0, 0
    v_pk_mov_b32 v[188:189], 0, 0
    v_pk_mov_b32 v[236:237], 0, 0
    v_mfma_f32_16x16x32_bf16 v[160:163], v[152:155], v[20:23], 0
    v_permlane16_swap_b32 v134, v138
    v_permlane16_swap_b32 v135, v139
    v_cvt_pk_bf16_f32 v238, v64, v65
    v_cvt_pk_bf16_f32 v239, v66, v67
    v_permlane16_swap_b32 v150, v154
    v_permlane16_swap_b32 v151, v155
    v_mfma_f32_16x16x32_bf16 v[228:231], v[136:139], v[132:135], v[28:31]
    v_cvt_pk_bf16_f32 v240, v80, v81
    v_cvt_pk_bf16_f32 v241, v82, v83
    v_mfma_f32_16x16x32_bf16 v[140:143], v[120:123], v[132:135], v[32:35]
    v_cvt_pk_bf16_f32 v242, v96, v97
    v_cvt_pk_bf16_f32 v243, v98, v99
    v_mfma_f32_16x16x32_bf16 v[232:235], v[152:155], v[148:151], v[28:31]
    v_cvt_pk_bf16_f32 v244, v112, v113
    v_cvt_pk_bf16_f32 v245, v114, v115
    v_mfma_f32_16x16x32_bf16 v[156:159], v[136:139], v[148:151], v[32:35]
    v_cvt_pk_bf16_f32 v246, v128, v129
    v_cvt_pk_bf16_f32 v247, v130, v131
    v_cvt_pk_bf16_f32 v248, v144, v145
    v_cvt_pk_bf16_f32 v249, v146, v147
    v_cvt_pk_bf16_f32 v250, v160, v161
    v_cvt_pk_bf16_f32 v251, v162, v163
    s_mov_b64 exec, s[72:73]
    v_pk_mov_b32 v[212:213], v[76:77], v[76:77] op_sel:[0,1]
    v_pk_mov_b32 v[214:215], v[78:79], v[78:79] op_sel:[0,1]
    v_pk_mov_b32 v[216:217], v[92:93], v[92:93] op_sel:[0,1]
    v_pk_mov_b32 v[218:219], v[94:95], v[94:95] op_sel:[0,1]
    v_pk_mov_b32 v[220:221], v[108:109], v[108:109] op_sel:[0,1]
    v_pk_mov_b32 v[222:223], v[110:111], v[110:111] op_sel:[0,1]
    v_pk_mov_b32 v[224:225], v[124:125], v[124:125] op_sel:[0,1]
    v_pk_mov_b32 v[226:227], v[126:127], v[126:127] op_sel:[0,1]
    v_pk_mov_b32 v[228:229], v[140:141], v[140:141] op_sel:[0,1]
    v_pk_mov_b32 v[230:231], v[142:143], v[142:143] op_sel:[0,1]
    v_pk_mov_b32 v[232:233], v[156:157], v[156:157] op_sel:[0,1]
    v_pk_mov_b32 v[234:235], v[158:159], v[158:159] op_sel:[0,1]
    s_mov_b64 exec, -1
    v_max3_f32 v156, v232, v233, v234
    v_max3_f32 v124, v224, v225, v226
    v_max3_f32 v140, v228, v229, v230
    v_max3_f32 v60, v208, v209, v210
    v_max3_f32 v76, v212, v213, v214
    v_max3_f32 v92, v216, v217, v218
    v_max3_f32 v108, v220, v221, v222
    v_max_f32 v158, v156, v235
    v_max_f32 v156, v156, v235
    v_max_f32 v124, v124, v227
    v_max_f32 v140, v140, v231
    v_max_f32 v60, v60, v211
    v_max_f32 v76, v76, v215
    v_max_f32 v92, v92, v219
    v_max_f32 v108, v108, v223
    v_permlane32_swap_b32 v156, v158
    v_permlane32_swap_b32 v124, v140
    v_permlane32_swap_b32 v60, v76
    v_permlane32_swap_b32 v92, v108
    v_max_f32 v156, v156, v158
    v_max_f32 v124, v124, v140
    v_max_f32 v60, v60, v76
    v_max_f32 v92, v92, v108
    v_permlane16_swap_b32 v124, v156
    s_nop 0
    v_permlane16_swap_b32 v60, v92
    v_max_f32 v124, v124, v156
    v_max_f32 v60, v60, v92
    v_mul_f32 v156, s70, v124
    v_mul_f32 v124, s70, v124
    v_mul_f32 v92, s70, v60
    v_mul_f32 v60, s70, v60
    v_permlane16_swap_b32 v124, v156
    s_nop 0
    v_permlane16_swap_b32 v60, v92
    v_mov_b32 v140, v124
    v_mov_b32 v76, v60
    v_mov_b32 v108, v92
    v_pk_fma_f32 v[232:233], v[232:233], s[70:71], v[156:157] op_sel_hi:[1,0,0] neg_lo:[0,0,1] neg_hi:[0,0,1]
    v_pk_fma_f32 v[234:235], v[234:235], s[70:71], v[156:157] op_sel_hi:[1,0,0] neg_lo:[0,0,1] neg_hi:[0,0,1]
    v_permlane32_swap_b32 v124, v140
    v_permlane32_swap_b32 v60, v76
    v_permlane32_swap_b32 v92, v108
    v_exp_f32 v232, v232
    v_exp_f32 v233, v233
    v_exp_f32 v234, v234
    v_exp_f32 v235, v235
    v_pk_fma_f32 v[224:225], v[224:225], s[70:71], v[124:125] op_sel_hi:[1,0,0] neg_lo:[0,0,1] neg_hi:[0,0,1]
    v_pk_fma_f32 v[226:227], v[226:227], s[70:71], v[124:125] op_sel_hi:[1,0,0] neg_lo:[0,0,1] neg_hi:[0,0,1]
    v_pk_fma_f32 v[228:229], v[228:229], s[70:71], v[140:141] op_sel_hi:[1,0,0] neg_lo:[0,0,1] neg_hi:[0,0,1]
    v_pk_fma_f32 v[230:231], v[230:231], s[70:71], v[140:141] op_sel_hi:[1,0,0] neg_lo:[0,0,1] neg_hi:[0,0,1]
    v_exp_f32 v224, v224
    v_exp_f32 v225, v225
    v_exp_f32 v226, v226
    v_exp_f32 v227, v227
    v_exp_f32 v228, v228
    v_exp_f32 v229, v229
    v_exp_f32 v230, v230
    v_exp_f32 v231, v231
    v_pk_fma_f32 v[208:209], v[208:209], s[70:71], v[60:61] op_sel_hi:[1,0,0] neg_lo:[0,0,1] neg_hi:[0,0,1]
    v_pk_fma_f32 v[210:211], v[210:211], s[70:71], v[60:61] op_sel_hi:[1,0,0] neg_lo:[0,0,1] neg_hi:[0,0,1]
    v_pk_fma_f32 v[212:213], v[212:213], s[70:71], v[76:77] op_sel_hi:[1,0,0] neg_lo:[0,0,1] neg_hi:[0,0,1]
    v_pk_fma_f32 v[214:215], v[214:215], s[70:71], v[76:77] op_sel_hi:[1,0,0] neg_lo:[0,0,1] neg_hi:[0,0,1]
    v_pk_fma_f32 v[216:217], v[216:217], s[70:71], v[92:93] op_sel_hi:[1,0,0] neg_lo:[0,0,1] neg_hi:[0,0,1]
    v_pk_fma_f32 v[218:219], v[218:219], s[70:71], v[92:93] op_sel_hi:[1,0,0] neg_lo:[0,0,1] neg_hi:[0,0,1]
    v_pk_fma_f32 v[220:221], v[220:221], s[70:71], v[108:109] op_sel_hi:[1,0,0] neg_lo:[0,0,1] neg_hi:[0,0,1]
    v_pk_fma_f32 v[222:223], v[222:223], s[70:71], v[108:109] op_sel_hi:[1,0,0] neg_lo:[0,0,1] neg_hi:[0,0,1]
    v_cvt_pk_bf16_f32 v190, v232, v233
    v_cvt_pk_bf16_f32 v191, v234, v235
    v_cvt_pk_bf16_f32 v182, v224, v225
    v_cvt_pk_bf16_f32 v183, v226, v227
    v_cvt_pk_bf16_f32 v186, v228, v229
    v_cvt_pk_bf16_f32 v187, v230, v231
    s_mov_b64 exec, s[72:73]
    v_pk_mov_b32 v[180:181], v[182:183], v[182:183] op_sel:[0,1]
    v_pk_mov_b32 v[184:185], v[186:187], v[186:187] op_sel:[0,1]
    v_pk_mov_b32 v[188:189], v[190:191], v[190:191] op_sel:[0,1]
    v_pk_mov_b32 v[182:183], 0, 0
    v_pk_mov_b32 v[186:187], 0, 0
    v_pk_mov_b32 v[190:191], 0, 0
    s_mov_b64 exec, -1
    s_nop 0
    v_mfma_f32_16x16x32_bf16 v[156:159], v[24:27], v[188:191], 0
    v_exp_f32 v208, v208
    v_mfma_f32_16x16x32_bf16 v[148:151], v[48:51], v[188:191], 0
    v_exp_f32 v209, v209
    v_mfma_f32_16x16x32_bf16 v[152:155], v[248:251], v[188:191], 0
    v_exp_f32 v210, v210
    v_mfma_f32_16x16x32_bf16 v[124:127], v[24:27], v[180:183], 0
    v_exp_f32 v211, v211
    v_mfma_f32_16x16x32_bf16 v[116:119], v[44:47], v[180:183], 0
    v_exp_f32 v212, v212
    v_mfma_f32_16x16x32_bf16 v[120:123], v[244:247], v[180:183], 0
    v_exp_f32 v213, v213
    v_mfma_f32_16x16x32_bf16 v[140:143], v[24:27], v[184:187], 0
    v_exp_f32 v214, v214
    v_mfma_f32_16x16x32_bf16 v[132:135], v[46:49], v[184:187], 0
    v_exp_f32 v215, v215
    v_mfma_f32_16x16x32_bf16 v[136:139], v[246:249], v[184:187], 0
    v_exp_f32 v216, v216
    v_exp_f32 v217, v217
    v_exp_f32 v218, v218
    v_exp_f32 v219, v219
    v_exp_f32 v220, v220
    v_exp_f32 v221, v221
    v_exp_f32 v222, v222
    v_exp_f32 v223, v223
    v_rcp_f32 v156, v156
    v_rcp_f32 v124, v124
    v_cvt_pk_bf16_f32 v166, v208, v209
    v_cvt_pk_bf16_f32 v167, v210, v211
    v_cvt_pk_bf16_f32 v170, v212, v213
    v_cvt_pk_bf16_f32 v171, v214, v215
    v_cvt_pk_bf16_f32 v174, v216, v217
    v_cvt_pk_bf16_f32 v175, v218, v219
    v_cvt_pk_bf16_f32 v178, v220, v221
    v_cvt_pk_bf16_f32 v179, v222, v223
    v_rcp_f32 v140, v140
    s_mov_b64 exec, s[72:73]
    v_pk_mov_b32 v[168:169], v[170:171], v[170:171] op_sel:[0,1]
    v_pk_mov_b32 v[172:173], v[174:175], v[174:175] op_sel:[0,1]
    v_pk_mov_b32 v[176:177], v[178:179], v[178:179] op_sel:[0,1]
    v_pk_mov_b32 v[170:171], 0, 0
    v_pk_mov_b32 v[174:175], 0, 0
    v_pk_mov_b32 v[178:179], 0, 0
    s_mov_b64 exec, -1
    v_mfma_f32_16x16x32_bf16 v[60:63], v[24:27], v[164:167], 0
    v_pk_mul_f32 v[148:149], v[148:149], v[156:157] op_sel_hi:[1,0]
    v_pk_mul_f32 v[150:151], v[150:151], v[156:157] op_sel_hi:[1,0]
    v_mfma_f32_16x16x32_bf16 v[52:55], v[36:39], v[164:167], 0
    v_pk_mul_f32 v[116:117], v[116:117], v[124:125] op_sel_hi:[1,0]
    v_pk_mul_f32 v[118:119], v[118:119], v[124:125] op_sel_hi:[1,0]
    v_mfma_f32_16x16x32_bf16 v[56:59], v[236:239], v[164:167], 0
    v_pk_mul_f32 v[132:133], v[132:133], v[140:141] op_sel_hi:[1,0]
    v_pk_mul_f32 v[134:135], v[134:135], v[140:141] op_sel_hi:[1,0]
    v_mfma_f32_16x16x32_bf16 v[76:79], v[24:27], v[168:171], 0
    v_cvt_pk_bf16_f32 v160, v148, v149
    v_cvt_pk_bf16_f32 v161, v150, v151
    v_mfma_f32_16x16x32_bf16 v[68:71], v[38:41], v[168:171], 0
    ds_write_b64 v7, v[160:161] offset:16896
    v_cvt_pk_bf16_f32 v128, v116, v117
    v_mfma_f32_16x16x32_bf16 v[72:75], v[238:241], v[168:171], 0
    v_cvt_pk_bf16_f32 v129, v118, v119
    ds_write_b64 v7, v[128:129] offset:11264
    v_mfma_f32_16x16x32_bf16 v[92:95], v[24:27], v[172:175], 0
    v_cvt_pk_bf16_f32 v144, v132, v133
    v_cvt_pk_bf16_f32 v145, v134, v135
    v_mfma_f32_16x16x32_bf16 v[84:87], v[40:43], v[172:175], 0
    ds_write_b64 v7, v[144:145] offset:14080
    v_mfma_f32_16x16x32_bf16 v[88:91], v[240:243], v[172:175], 0
    v_mfma_f32_16x16x32_bf16 v[108:111], v[24:27], v[176:179], 0
    v_mfma_f32_16x16x32_bf16 v[100:103], v[42:45], v[176:179], 0
    v_mfma_f32_16x16x32_bf16 v[104:107], v[242:245], v[176:179], 0
    s_mov_b64 exec, 0xffff
    v_pk_mul_f32 v[196:197], v[120:121], v[124:125] op_sel_hi:[1,0]
    v_pk_mul_f32 v[198:199], v[122:123], v[124:125] op_sel_hi:[1,0]
    s_lshl_b64 exec, exec, 16
    v_pk_mul_f32 v[196:197], v[136:137], v[140:141] op_sel_hi:[1,0]
    v_pk_mul_f32 v[198:199], v[138:139], v[140:141] op_sel_hi:[1,0]
    s_lshl_b64 exec, exec, 16
    v_pk_mul_f32 v[196:197], v[152:153], v[156:157] op_sel_hi:[1,0]
    v_pk_mul_f32 v[198:199], v[154:155], v[156:157] op_sel_hi:[1,0]
    s_mov_b64 exec, -1
    s_mov_b32 exec_hi, 0xffff
    v_cvt_pk_bf16_f32 v196, v196, v197
    v_cvt_pk_bf16_f32 v197, v198, v199
    ds_write_b64 v8, v[196:197] offset:11264
    s_mov_b32 exec_hi, -1
    v_rcp_f32 v60, v60
    v_rcp_f32 v76, v76
    v_rcp_f32 v92, v92
    v_rcp_f32 v108, v108
    v_pk_mul_f32 v[52:53], v[52:53], v[60:61] op_sel_hi:[1,0]
    v_pk_mul_f32 v[54:55], v[54:55], v[60:61] op_sel_hi:[1,0]
    v_pk_mul_f32 v[68:69], v[68:69], v[76:77] op_sel_hi:[1,0]
    v_pk_mul_f32 v[70:71], v[70:71], v[76:77] op_sel_hi:[1,0]
    v_pk_mul_f32 v[84:85], v[84:85], v[92:93] op_sel_hi:[1,0]
    v_pk_mul_f32 v[86:87], v[86:87], v[92:93] op_sel_hi:[1,0]
    v_pk_mul_f32 v[100:101], v[100:101], v[108:109] op_sel_hi:[1,0]
    v_pk_mul_f32 v[102:103], v[102:103], v[108:109] op_sel_hi:[1,0]
    v_cvt_pk_bf16_f32 v64, v52, v53
    v_cvt_pk_bf16_f32 v65, v54, v55
    ds_write_b64 v7, v[64:65] offset:0
    v_cvt_pk_bf16_f32 v80, v68, v69
    v_cvt_pk_bf16_f32 v81, v70, v71
    ds_write_b64 v7, v[80:81] offset:2816
    v_cvt_pk_bf16_f32 v96, v84, v85
    v_cvt_pk_bf16_f32 v97, v86, v87
    ds_write_b64 v7, v[96:97] offset:5632
    v_cvt_pk_bf16_f32 v112, v100, v101
    v_cvt_pk_bf16_f32 v113, v102, v103
    ds_write_b64 v7, v[112:113] offset:8448
    s_mov_b64 exec, 0xffff
    v_pk_mul_f32 v[192:193], v[56:57], v[60:61] op_sel_hi:[1,0]
    v_pk_mul_f32 v[194:195], v[58:59], v[60:61] op_sel_hi:[1,0]
    s_lshl_b64 exec, exec, 16
    v_pk_mul_f32 v[192:193], v[72:73], v[76:77] op_sel_hi:[1,0]
    v_pk_mul_f32 v[194:195], v[74:75], v[76:77] op_sel_hi:[1,0]
    s_lshl_b64 exec, exec, 16
    v_pk_mul_f32 v[192:193], v[88:89], v[92:93] op_sel_hi:[1,0]
    v_pk_mul_f32 v[194:195], v[90:91], v[92:93] op_sel_hi:[1,0]
    s_lshl_b64 exec, exec, 16
    v_pk_mul_f32 v[192:193], v[104:105], v[108:109] op_sel_hi:[1,0]
    v_pk_mul_f32 v[194:195], v[106:107], v[108:109] op_sel_hi:[1,0]
    s_mov_b64 exec, -1
    v_cvt_pk_bf16_f32 v192, v192, v193
    v_cvt_pk_bf16_f32 v193, v194, v195
    ds_write_b64 v8, v[192:193] offset:0
    s_waitcnt lgkmcnt(0)
    s_barrier
    ds_read_b128 v[168:171], v10
    ds_read_b128 v[172:175], v11
    ds_read_b128 v[176:179], v12
    ds_read_b128 v[180:183], v13
    ds_read_b128 v[184:187], v252
    s_mov_b64 exec, s[28:29]
    s_waitcnt lgkmcnt(4)
    buffer_store_dwordx4 v[168:171], v19, s[36:39], s74 offen sc1
    s_mov_b64 exec, s[30:31]
    s_waitcnt lgkmcnt(3)
    buffer_store_dwordx4 v[172:175], v19, s[36:39], s75 offen sc1
    s_mov_b64 exec, s[32:33]
    s_waitcnt lgkmcnt(2)
    buffer_store_dwordx4 v[176:179], v19, s[36:39], s76 offen sc1
    s_mov_b64 exec, s[34:35]
    s_waitcnt lgkmcnt(1)
    buffer_store_dwordx4 v[180:183], v19, s[36:39], s77 offen sc1
    s_mov_b64 exec, -1
    s_waitcnt lgkmcnt(0)
    buffer_store_dwordx4 v[184:187], v253, s[36:39], 0 offen sc1
L_P2:
    s_lshr_b32 s56, s3, 2
    v_and_b32 v2, 15, v0
    v_lshrrev_b32 v3, 4, v0
    v_bfe_u32 v4, v0, 2, 3
    v_lshrrev_b32 v5, 5, v0
    v_lshl_add_u32 v4, v5, 4, v4
    v_mul_u32_u24 v4, 160, v4
    v_and_b32 v5, 3, v0
    v_lshl_add_u32 v4, v5, 3, v4
    s_mul_i32 s58, s56, 35840
    v_add_u32 v8, s58, v4
    s_mul_i32 s58, s56, 15360
    s_add_u32 s58, s58, 71680
    v_add_u32 v9, s58, v4
    ds_read_b64_tr_b16 v[28:29], v8 offset:0
    ds_read_b64_tr_b16 v[30:31], v8 offset:1280
    ds_read_b64_tr_b16 v[32:33], v8 offset:32
    ds_read_b64_tr_b16 v[34:35], v8 offset:1312
    ds_read_b64_tr_b16 v[36:37], v8 offset:64
    ds_read_b64_tr_b16 v[38:39], v8 offset:1344
    ds_read_b64_tr_b16 v[40:41], v8 offset:96
    ds_read_b64_tr_b16 v[42:43], v8 offset:1376
    ds_read_b64_tr_b16 v[44:45], v8 offset:128
    ds_read_b64_tr_b16 v[46:47], v8 offset:1408
    s_mul_i32 s57, s53, 1280
    s_mul_i32 s58, s52, 160
    s_add_u32 s57, s57, s58
    s_lshl_b32 s58, s3, 6
    s_add_u32 s58, s58, 0
    s_mov_b32 s59, 133120
    v_add_u32 v4, s58, v0
    v_mul_u32_u24 v5, 6554, v4
    v_lshrrev_b32 v5, 16, v5
    v_lshl_add_u32 v249, v5, 2, s59
    v_mul_u32_u24 v6, 10, v5
    v_sub_u32 v4, v4, v6
    v_mul_u32_u24 v6, 40960, v5
    v_lshl_add_u32 v6, v4, 4, v6
    v_add_u32 v26, s57, v6
    v_mul_u32_u24 v6, 336, v5
    v_lshl_add_u32 v4, v4, 5, v6
    v_lshrrev_b32 v5, 4, v5
    v_mul_u32_u24 v6, 4864, v5
    v_add_u32 v252, v4, v6
    v_add_u32 v5, 1, v5
    v_lshrrev_b32 v5, 2, v5
    v_mul_u32_u24 v5, 30720, v5
    v_add_u32 v253, v252, v5
    s_waitcnt lgkmcnt(5)
    ds_read_b64_tr_b16 v[48:49], v8 offset:5120
    ds_read_b64_tr_b16 v[50:51], v8 offset:6400
    ds_read_b64_tr_b16 v[52:53], v8 offset:5152
    ds_read_b64_tr_b16 v[54:55], v8 offset:6432
    ds_read_b64_tr_b16 v[56:57], v8 offset:5184
    ds_read_b64_tr_b16 v[58:59], v8 offset:6464
    ds_read_b64_tr_b16 v[60:61], v8 offset:5216
    ds_read_b64_tr_b16 v[62:63], v8 offset:6496
    ds_read_b64_tr_b16 v[64:65], v8 offset:5248
    ds_read_b64_tr_b16 v[66:67], v8 offset:6528
    s_mul_i32 s57, s53, 1280
    s_mul_i32 s58, s52, 160
    s_add_u32 s57, s57, s58
    s_lshl_b32 s58, s3, 6
    s_add_u32 s58, s58, 512
    s_mov_b32 s59, 133120
    v_add_u32 v4, s58, v0
    v_mul_u32_u24 v5, 6554, v4
    v_lshrrev_b32 v5, 16, v5
    v_lshl_add_u32 v251, v5, 2, s59
    v_mul_u32_u24 v6, 10, v5
    v_sub_u32 v4, v4, v6
    v_mul_u32_u24 v6, 40960, v5
    v_lshl_add_u32 v6, v4, 4, v6
    v_add_u32 v27, s57, v6
    v_mul_u32_u24 v6, 336, v5
    v_lshl_add_u32 v4, v4, 5, v6
    v_lshrrev_b32 v5, 4, v5
    v_mul_u32_u24 v6, 4864, v5
    v_add_u32 v254, v4, v6
    v_add_u32 v5, 1, v5
    v_lshrrev_b32 v5, 2, v5
    v_mul_u32_u24 v5, 30720, v5
    v_add_u32 v255, v254, v5
    s_cmp_ge_u32 s50, 20
    s_cbranch_scc1 L_NOFLAG
    s_mul_i32 s71, s50, 52
    s_lshr_b32 s71, s71, 8
    s_mul_i32 s72, s71, 5
    s_sub_u32 s72, s50, s72
    s_lshl_b32 s71, s71, 2
    s_add_u32 s71, s71, s49
    s_lshl_b32 s71, 1, s71
    s_lshl_b32 s72, s72, 7
    s_add_u32 s72, s72, 5439488
    v_and_b32 v16, 7, v0
    v_lshlrev_b32 v16, 13, v16
    v_and_b32 v17, 24, v0
    v_mul_u32_u24 v17, 80, v17
    v_add_u32 v16, v16, v17
    v_and_b32 v17, 32, v0
    v_lshl_add_u32 v16, v17, 7, v16
    v_mov_b32 v17, s71
    s_lshl_b32 s74, 0x55555555, s48
    s_lshl_b32 s75, 0x55555555, s48
    v_mov_b32 v4, 163832
    v_mov_b32 v5, 1
    s_mov_b64 exec, 1
    s_waitcnt vmcnt(0)
    ds_add_rtn_u32 v5, v4, v5
    s_waitcnt lgkmcnt(0)
    v_cmp_eq_u32 vcc, 3, v5
    s_cbranch_vccz L_NOFL2
    s_mov_b64 exec, s[74:75]
    buffer_atomic_or v17, v16, s[36:39], s72 offen sc1
L_NOFL2:
    s_mov_b64 exec, -1
L_NOFLAG:
    s_waitcnt lgkmcnt(5)
    ds_read_b64_tr_b16 v[68:69], v8 offset:10240
    ds_read_b64_tr_b16 v[70:71], v8 offset:11520
    ds_read_b64_tr_b16 v[72:73], v8 offset:10272
    ds_read_b64_tr_b16 v[74:75], v8 offset:11552
    ds_read_b64_tr_b16 v[76:77], v8 offset:10304
    ds_read_b64_tr_b16 v[78:79], v8 offset:11584
    ds_read_b64_tr_b16 v[80:81], v8 offset:10336
    ds_read_b64_tr_b16 v[82:83], v8 offset:11616
    ds_read_b64_tr_b16 v[84:85], v8 offset:10368
    ds_read_b64_tr_b16 v[86:87], v8 offset:11648
    s_lshl_b32 s57, s56, 1
    s_add_u32 s57, s57, s52
    s_add_u32 s57, s57, 0
    s_and_b32 s57, s57, 3
    s_lshl_b32 s58, s53, 2
    s_add_u32 s57, s57, s58
    s_lshl_b32 s57, s57, 3
    s_add_u32 s57, s57, s51
    s_mul_i32 s62, s57, 2560
    s_lshl_b32 s57, s56, 1
    s_add_u32 s57, s57, s52
    s_add_u32 s57, s57, 1
    s_and_b32 s57, s57, 3
    s_lshl_b32 s58, s53, 2
    s_add_u32 s57, s57, s58
    s_lshl_b32 s57, s57, 3
    s_add_u32 s57, s57, s51
    s_mul_i32 s63, s57, 2560
    s_mul_i32 s61, s3, 10240
    s_cmp_eq_u32 s3, 7
    s_cselect_b32 s61, 102400, s61
    v_and_b32 v4, 1, v3
    v_lshrrev_b32 v5, 1, v3
    v_xor_b32 v5, v5, v4
    v_mul_u32_u24 v4, 2560, v4
    v_lshl_add_u32 v4, v5, 4, v4
    v_mul_u32_u24 v5, 160, v2
    v_add3_u32 v20, v4, v5, s61
    v_mul_u32_u24 v22, 336, v2
    v_lshl_add_u32 v22, v3, 4, v22
    v_add_u32 v22, s61, v22
    s_waitcnt lgkmcnt(5)
    ds_read_b64_tr_b16 v[88:89], v8 offset:15360
    ds_read_b64_tr_b16 v[90:91], v8 offset:16640
    ds_read_b64_tr_b16 v[92:93], v8 offset:15392
    ds_read_b64_tr_b16 v[94:95], v8 offset:16672
    ds_read_b64_tr_b16 v[96:97], v8 offset:15424
    ds_read_b64_tr_b16 v[98:99], v8 offset:16704
    ds_read_b64_tr_b16 v[100:101], v8 offset:15456
    ds_read_b64_tr_b16 v[102:103], v8 offset:16736
    ds_read_b64_tr_b16 v[104:105], v8 offset:15488
    ds_read_b64_tr_b16 v[106:107], v8 offset:16768
    v_lshlrev_b32 v10, 4, v0
    v_mov_b32 v11, v10
    v_xor_b32 v4, 16, v10
    v_add_u32 v13, 7680, v4
    v_add_u32 v14, 11776, v4
    v_add_u32 v12, 7680, v4
    s_mov_b32 exec_hi, 0
    v_mov_b32 v12, v10
    s_mov_b32 exec_hi, -1
    s_waitcnt lgkmcnt(5)
    ds_read_b64_tr_b16 v[108:109], v8 offset:20480
    ds_read_b64_tr_b16 v[110:111], v8 offset:21760
    ds_read_b64_tr_b16 v[112:113], v8 offset:20512
    ds_read_b64_tr_b16 v[114:115], v8 offset:21792
    ds_read_b64_tr_b16 v[116:117], v8 offset:20544
    ds_read_b64_tr_b16 v[118:119], v8 offset:21824
    ds_read_b64_tr_b16 v[120:121], v8 offset:20576
    ds_read_b64_tr_b16 v[122:123], v8 offset:21856
    ds_read_b64_tr_b16 v[124:125], v8 offset:20608
    ds_read_b64_tr_b16 v[126:127], v8 offset:21888
    s_waitcnt lgkmcnt(5)
    ds_read_b64_tr_b16 v[128:129], v8 offset:25600
    ds_read_b64_tr_b16 v[130:131], v8 offset:26880
    ds_read_b64_tr_b16 v[132:133], v8 offset:25632
    ds_read_b64_tr_b16 v[134:135], v8 offset:26912
    ds_read_b64_tr_b16 v[136:137], v8 offset:25664
    ds_read_b64_tr_b16 v[138:139], v8 offset:26944
    ds_read_b64_tr_b16 v[140:141], v8 offset:25696
    ds_read_b64_tr_b16 v[142:143], v8 offset:26976
    ds_read_b64_tr_b16 v[144:145], v8 offset:25728
    ds_read_b64_tr_b16 v[146:147], v8 offset:27008
    s_waitcnt lgkmcnt(5)
    ds_read_b64_tr_b16 v[148:149], v8 offset:30720
    ds_read_b64_tr_b16 v[150:151], v8 offset:32000
    ds_read_b64_tr_b16 v[152:153], v8 offset:30752
    ds_read_b64_tr_b16 v[154:155], v8 offset:32032
    ds_read_b64_tr_b16 v[156:157], v8 offset:30784
    ds_read_b64_tr_b16 v[158:159], v8 offset:32064
    ds_read_b64_tr_b16 v[160:161], v8 offset:30816
    ds_read_b64_tr_b16 v[162:163], v8 offset:32096
    ds_read_b64_tr_b16 v[164:165], v8 offset:30848
    ds_read_b64_tr_b16 v[166:167], v8 offset:32128
    s_waitcnt lgkmcnt(5)
    ds_read_b64_tr_b16 v[208:209], v9 offset:0
    ds_read_b64_tr_b16 v[210:211], v9 offset:1280
    ds_read_b64_tr_b16 v[212:213], v9 offset:32
    ds_read_b64_tr_b16 v[214:215], v9 offset:1312
    ds_read_b64_tr_b16 v[216:217], v9 offset:64
    ds_read_b64_tr_b16 v[218:219], v9 offset:1344
    ds_read_b64_tr_b16 v[220:221], v9 offset:96
    ds_read_b64_tr_b16 v[222:223], v9 offset:1376
    ds_read_b64_tr_b16 v[224:225], v9 offset:128
    ds_read_b64_tr_b16 v[226:227], v9 offset:1408
    s_branch L_GO
L_P2H:
    s_lshr_b32 s56, s3, 2
    v_and_b32 v2, 15, v0
    v_lshrrev_b32 v3, 4, v0
    v_bfe_u32 v4, v0, 2, 3
    v_lshrrev_b32 v5, 5, v0
    v_lshl_add_u32 v4, v5, 4, v4
    v_mul_u32_u24 v4, 160, v4
    v_and_b32 v5, 3, v0
    v_lshl_add_u32 v4, v5, 3, v4
    s_mul_i32 s58, s56, 35840
    v_add_u32 v8, s58, v4
    s_mul_i32 s58, s56, 15360
    s_add_u32 s58, s58, 71680
    v_add_u32 v9, s58, v4
    s_mul_i32 s57, s53, 1280
    s_mul_i32 s58, s52, 160
    s_add_u32 s57, s57, s58
    s_lshl_b32 s58, s3, 6
    s_add_u32 s58, s58, 0
    s_mov_b32 s59, 133120
    v_add_u32 v4, s58, v0
    v_mul_u32_u24 v5, 6554, v4
    v_lshrrev_b32 v5, 16, v5
    v_lshl_add_u32 v249, v5, 2, s59
    v_mul_u32_u24 v6, 10, v5
    v_sub_u32 v4, v4, v6
    v_mul_u32_u24 v6, 40960, v5
    v_lshl_add_u32 v6, v4, 4, v6
    v_add_u32 v26, s57, v6
    v_mul_u32_u24 v6, 336, v5
    v_lshl_add_u32 v4, v4, 5, v6
    v_lshrrev_b32 v5, 4, v5
    v_mul_u32_u24 v6, 4864, v5
    v_add_u32 v252, v4, v6
    v_add_u32 v5, 1, v5
    v_lshrrev_b32 v5, 2, v5
    v_mul_u32_u24 v5, 30720, v5
    v_add_u32 v253, v252, v5
    s_mul_i32 s57, s53, 1280
    s_mul_i32 s58, s52, 160
    s_add_u32 s57, s57, s58
    s_lshl_b32 s58, s3, 6
    s_add_u32 s58, s58, 512
    s_mov_b32 s59, 133120
    v_add_u32 v4, s58, v0
    v_mul_u32_u24 v5, 6554, v4
    v_lshrrev_b32 v5, 16, v5
    v_lshl_add_u32 v251, v5, 2, s59
    v_mul_u32_u24 v6, 10, v5
    v_sub_u32 v4, v4, v6
    v_mul_u32_u24 v6, 40960, v5
    v_lshl_add_u32 v6, v4, 4, v6
    v_add_u32 v27, s57, v6
    v_mul_u32_u24 v6, 336, v5
    v_lshl_add_u32 v4, v4, 5, v6
    v_lshrrev_b32 v5, 4, v5
    v_mul_u32_u24 v6, 4864, v5
    v_add_u32 v254, v4, v6
    v_add_u32 v5, 1, v5
    v_lshrrev_b32 v5, 2, v5
    v_mul_u32_u24 v5, 30720, v5
    v_add_u32 v255, v254, v5
    s_lshl_b32 s57, s56, 1
    s_add_u32 s57, s57, s52
    s_add_u32 s57, s57, 0
    s_and_b32 s57, s57, 3
    s_lshl_b32 s58, s53, 2
    s_add_u32 s57, s57, s58
    s_lshl_b32 s57, s57, 3
    s_add_u32 s57, s57, s51
    s_mul_i32 s62, s57, 2560
    s_lshl_b32 s57, s56, 1
    s_add_u32 s57, s57, s52
    s_add_u32 s57, s57, 1
    s_and_b32 s57, s57, 3
    s_lshl_b32 s58, s53, 2
    s_add_u32 s57, s57, s58
    s_lshl_b32 s57, s57, 3
    s_add_u32 s57, s57, s51
    s_mul_i32 s63, s57, 2560
    s_mul_i32 s61, s3, 10240
    s_cmp_eq_u32 s3, 7
    s_cselect_b32 s61, 102400, s61
    v_and_b32 v4, 1, v3
    v_lshrrev_b32 v5, 1, v3
    v_xor_b32 v5, v5, v4
    v_mul_u32_u24 v4, 2560, v4
    v_lshl_add_u32 v4, v5, 4, v4
    v_mul_u32_u24 v5, 160, v2
    v_add3_u32 v20, v4, v5, s61
    v_mul_u32_u24 v22, 336, v2
    v_lshl_add_u32 v22, v3, 4, v22
    v_add_u32 v22, s61, v22
    v_lshlrev_b32 v10, 4, v0
    v_mov_b32 v11, v10
    v_xor_b32 v4, 16, v10
    v_add_u32 v13, 7680, v4
    v_add_u32 v14, 11776, v4
    v_add_u32 v12, 7680, v4
    s_mov_b32 exec_hi, 0
    v_mov_b32 v12, v10
    s_mov_b32 exec_hi, -1
    s_and_b32 s65, s2, 7
    s_lshl_b32 s65, s65, 13
    s_add_u32 s65, s65, 5439488
    s_and_b32 s70, s50, 3
    s_mul_i32 s70, s70, 640
    s_add_u32 s60, s65, s70
    s_and_b32 s70, s50, 4
    s_lshl_b32 s70, s70, 10
    s_add_u32 s60, s60, s70
    v_lshlrev_b32 v21, 7, v0
    v_and_b32 v4, 1, v2
    v_mul_u32_u24 v4, 640, v4
    v_lshrrev_b32 v5, 1, v2
    v_lshl_add_u32 v4, v5, 4, v4
    v_mul_u32_u24 v5, 5120, v3
    s_mov_b32 s57, 112640
    v_add3_u32 v23, v4, v5, s57
    s_lshl_b32 s57, s51, 6
    s_add_u32 s57, s57, 133120
    v_lshlrev_b32 v7, 2, v2
    v_add_u32 v7, s57, v7
    s_mul_i32 s71, s50, 52
    s_lshr_b32 s71, s71, 8
    s_mul_i32 s70, s71, 5
    s_sub_u32 s70, s50, s70
    s_lshl_b32 s71, s71, 2
    s_add_u32 s71, s71, s49
    s_lshl_b32 s71, 1, s71
    s_and_b32 s71, s71, 65535
    v_mov_b32 v4, s71
    v_cmp_eq_u32 vcc, s70, v0
    s_nop 1
    v_cndmask_b32_e64 v192, 0, v4, vcc
    v_mov_b32 v196, v77
    v_mov_b32 v197, v78
    v_mov_b32 v198, v79
    v_mov_b32 v199, v80
    v_mov_b32 v200, v81
L_P2H2:
    s_waitcnt vmcnt(0)
    s_barrier
    ds_read_b64_tr_b16 v[28:29], v8 offset:0
    ds_read_b64_tr_b16 v[30:31], v8 offset:1280
    ds_read_b64_tr_b16 v[32:33], v8 offset:32
    ds_read_b64_tr_b16 v[34:35], v8 offset:1312
    ds_read_b64_tr_b16 v[36:37], v8 offset:64
    ds_read_b64_tr_b16 v[38:39], v8 offset:1344
    ds_read_b64_tr_b16 v[40:41], v8 offset:96
    ds_read_b64_tr_b16 v[42:43], v8 offset:1376
    ds_read_b64_tr_b16 v[44:45], v8 offset:128
    ds_read_b64_tr_b16 v[46:47], v8 offset:1408
    s_cmp_lg_u32 s3, 5
    s_cbranch_scc1 L_ND0
    s_mov_b32 exec_lo, 0xfff00000
    s_mov_b32 exec_hi, 0xfff00000
    v_mov_b32 v228, 0
    buffer_atomic_or v228, v21, s[36:39], s65 offen sc0 sc1
    s_mov_b64 exec, -1
L_ND0:
    s_waitcnt lgkmcnt(5)
    ds_read_b64_tr_b16 v[48:49], v8 offset:5120
    ds_read_b64_tr_b16 v[50:51], v8 offset:6400
    ds_read_b64_tr_b16 v[52:53], v8 offset:5152
    ds_read_b64_tr_b16 v[54:55], v8 offset:6432
    ds_read_b64_tr_b16 v[56:57], v8 offset:5184
    ds_read_b64_tr_b16 v[58:59], v8 offset:6464
    ds_read_b64_tr_b16 v[60:61], v8 offset:5216
    ds_read_b64_tr_b16 v[62:63], v8 offset:6496
    ds_read_b64_tr_b16 v[64:65], v8 offset:5248
    ds_read_b64_tr_b16 v[66:67], v8 offset:6528
    s_waitcnt lgkmcnt(5)
    ds_read_b64_tr_b16 v[68:69], v8 offset:10240
    ds_read_b64_tr_b16 v[70:71], v8 offset:11520
    ds_read_b64_tr_b16 v[72:73], v8 offset:10272
    ds_read_b64_tr_b16 v[74:75], v8 offset:11552
    ds_read_b64_tr_b16 v[76:77], v8 offset:10304
    ds_read_b64_tr_b16 v[78:79], v8 offset:11584
    ds_read_b64_tr_b16 v[80:81], v8 offset:10336
    ds_read_b64_tr_b16 v[82:83], v8 offset:11616
    ds_read_b64_tr_b16 v[84:85], v8 offset:10368
    ds_read_b64_tr_b16 v[86:87], v8 offset:11648
    s_waitcnt lgkmcnt(5)
    ds_read_b64_tr_b16 v[88:89], v8 offset:15360
    ds_read_b64_tr_b16 v[90:91], v8 offset:16640
    ds_read_b64_tr_b16 v[92:93], v8 offset:15392
    ds_read_b64_tr_b16 v[94:95], v8 offset:16672
    ds_read_b64_tr_b16 v[96:97], v8 offset:15424
    ds_read_b64_tr_b16 v[98:99], v8 offset:16704
    ds_read_b64_tr_b16 v[100:101], v8 offset:15456
    ds_read_b64_tr_b16 v[102:103], v8 offset:16736
    ds_read_b64_tr_b16 v[104:105], v8 offset:15488
    ds_read_b64_tr_b16 v[106:107], v8 offset:16768
    s_waitcnt lgkmcnt(5)
    ds_read_b64_tr_b16 v[108:109], v8 offset:20480
    ds_read_b64_tr_b16 v[110:111], v8 offset:21760
    ds_read_b64_tr_b16 v[112:113], v8 offset:20512
    ds_read_b64_tr_b16 v[114:115], v8 offset:21792
    ds_read_b64_tr_b16 v[116:117], v8 offset:20544
    ds_read_b64_tr_b16 v[118:119], v8 offset:21824
    ds_read_b64_tr_b16 v[120:121], v8 offset:20576
    ds_read_b64_tr_b16 v[122:123], v8 offset:21856
    ds_read_b64_tr_b16 v[124:125], v8 offset:20608
    ds_read_b64_tr_b16 v[126:127], v8 offset:21888
    s_waitcnt lgkmcnt(5)
    ds_read_b64_tr_b16 v[128:129], v8 offset:25600
    ds_read_b64_tr_b16 v[130:131], v8 offset:26880
    ds_read_b64_tr_b16 v[132:133], v8 offset:25632
    ds_read_b64_tr_b16 v[134:135], v8 offset:26912
    ds_read_b64_tr_b16 v[136:137], v8 offset:25664
    ds_read_b64_tr_b16 v[138:139], v8 offset:26944
    ds_read_b64_tr_b16 v[140:141], v8 offset:25696
    ds_read_b64_tr_b16 v[142:143], v8 offset:26976
    ds_read_b64_tr_b16 v[144:145], v8 offset:25728
    ds_read_b64_tr_b16 v[146:147], v8 offset:27008
    s_waitcnt lgkmcnt(5)
    ds_read_b64_tr_b16 v[148:149], v8 offset:30720
    ds_read_b64_tr_b16 v[150:151], v8 offset:32000
    ds_read_b64_tr_b16 v[152:153], v8 offset:30752
    ds_read_b64_tr_b16 v[154:155], v8 offset:32032
    ds_read_b64_tr_b16 v[156:157], v8 offset:30784
    ds_read_b64_tr_b16 v[158:159], v8 offset:32064
    ds_read_b64_tr_b16 v[160:161], v8 offset:30816
    ds_read_b64_tr_b16 v[162:163], v8 offset:32096
    ds_read_b64_tr_b16 v[164:165], v8 offset:30848
    ds_read_b64_tr_b16 v[166:167], v8 offset:32128
    s_waitcnt lgkmcnt(5)
    ds_read_b64_tr_b16 v[208:209], v9 offset:0
    ds_read_b64_tr_b16 v[210:211], v9 offset:1280
    ds_read_b64_tr_b16 v[212:213], v9 offset:32
    ds_read_b64_tr_b16 v[214:215], v9 offset:1312
    ds_read_b64_tr_b16 v[216:217], v9 offset:64
    ds_read_b64_tr_b16 v[218:219], v9 offset:1344
    ds_read_b64_tr_b16 v[220:221], v9 offset:96
    ds_read_b64_tr_b16 v[222:223], v9 offset:1376
    ds_read_b64_tr_b16 v[224:225], v9 offset:128
    ds_read_b64_tr_b16 v[226:227], v9 offset:1408
    s_cmp_lg_u32 s3, 5
    s_cbranch_scc1 L_GDONE
    s_mov_b32 exec_lo, 0xfff00000
    s_mov_b32 exec_hi, 0xfff00000
    s_mov_b32 s71, 0
    s_waitcnt vmcnt(0)
L_DPOLL:
    v_cmp_ne_u32 vcc, 15, v228
    s_cbranch_vccz L_GOK
    s_mov_b64 exec, vcc
    s_sleep 8
    v_mov_b32 v228, 0
    buffer_atomic_or v228, v21, s[36:39], s65 offen sc0 sc1
    s_add_u32 s71, s71, 1
    s_cmp_gt_u32 s71, 200000
    s_waitcnt vmcnt(0)
    s_cbranch_scc0 L_DPOLL
L_GOK:
    s_mov_b64 exec, -1
    s_mov_b32 m0, 112640
    s_mov_b32 s70, 0
    buffer_load_dwordx4 v196, s[36:39], s70 offen offset:0 sc1 lds
    buffer_load_dwordx4 v197, s[36:39], s70 offen offset:1024 sc1 lds
    buffer_load_dwordx4 v198, s[36:39], s70 offen offset:2048 sc1 lds
    buffer_load_dwordx4 v199, s[36:39], s70 offen offset:3072 sc1 lds
    s_add_u32 m0, m0, 4096
    s_nop 0
    buffer_load_dwordx4 v200, s[36:39], s70 offen offset:0 sc1 lds
    s_mov_b32 m0, 117760
    s_mov_b32 s70, 21504
    buffer_load_dwordx4 v196, s[36:39], s70 offen offset:0 sc1 lds
    buffer_load_dwordx4 v197, s[36:39], s70 offen offset:1024 sc1 lds
    buffer_load_dwordx4 v198, s[36:39], s70 offen offset:2048 sc1 lds
    buffer_load_dwordx4 v199, s[36:39], s70 offen offset:3072 sc1 lds
    s_add_u32 m0, m0, 4096
    s_nop 0
    buffer_load_dwordx4 v200, s[36:39], s70 offen offset:0 sc1 lds
    s_mov_b32 m0, 122880
    s_mov_b32 s70, 43008
    buffer_load_dwordx4 v196, s[36:39], s70 offen offset:0 sc1 lds
    buffer_load_dwordx4 v197, s[36:39], s70 offen offset:1024 sc1 lds
    buffer_load_dwordx4 v198, s[36:39], s70 offen offset:2048 sc1 lds
    buffer_load_dwordx4 v199, s[36:39], s70 offen offset:3072 sc1 lds
    s_add_u32 m0, m0, 4096
    s_nop 0
    buffer_load_dwordx4 v200, s[36:39], s70 offen offset:0 sc1 lds
    s_mov_b32 m0, 128000
    s_mov_b32 s70, 64512
    buffer_load_dwordx4 v196, s[36:39], s70 offen offset:0 sc1 lds
    buffer_load_dwordx4 v197, s[36:39], s70 offen offset:1024 sc1 lds
    buffer_load_dwordx4 v198, s[36:39], s70 offen offset:2048 sc1 lds
    buffer_load_dwordx4 v199, s[36:39], s70 offen offset:3072 sc1 lds
    s_add_u32 m0, m0, 4096
    s_nop 0
    buffer_load_dwordx4 v200, s[36:39], s70 offen offset:0 sc1 lds
    s_lshl_b32 s70, s53, 8
    s_add_u32 s70, s70, 5373952
    s_mov_b32 m0, 133120
    v_lshlrev_b32 v4, 2, v0
    buffer_load_dword v4, s[36:39], s70 offen sc1 lds
L_GDONE:
    s_cmp_lg_u32 s3, 4
    s_cbranch_scc1 L_NP0
    s_mov_b64 exec, 31
    v_mov_b32 v1, 0
    buffer_atomic_or v1, v21, s[36:39], s60 offen sc0 sc1
    s_mov_b64 exec, -1
L_NP0:
    s_lshl_b32 s70, s51, 9
    s_add_u32 s70, s70, s53
    v_and_b32 v176, 15, v0
    v_lshlrev_b32 v176, 5, v176
    v_add_u32 v176, s70, v176
    v_and_b32 v178, 48, v0
    v_mul_u32_u24 v178, v178, v176
    v_and_b32 v178, 0x7ff, v178
    s_cmp_lt_u32 s52, 4
    s_mov_b32 s73, 0x3a000000
    s_cselect_b32 s73, s73, 0xba000000
    v_cvt_f32_u32 v176, v176
    v_cvt_f32_u32 v178, v178
    v_mul_f32 v176, s73, v176
    v_mul_f32 v170, s73, v178
    v_add_f32 v171, v170, v176
    v_add_f32 v174, v176, v176
    v_cos_f32 v168, v170
    v_cos_f32 v169, v171
    v_cos_f32 v172, v174
    v_sin_f32 v170, v170
    v_sin_f32 v171, v171
    v_sin_f32 v174, v174
    s_nop 0
    v_pk_mul_f32 v[176:177], v[170:171], v[174:175] op_sel_hi:[1,0]
    v_pk_mul_f32 v[178:179], v[168:169], v[174:175] op_sel_hi:[1,0]
    v_cvt_pk_bf16_f32 v232, v168, v170
    v_cvt_pk_bf16_f32 v236, v169, v171
    v_pk_fma_f32 v[168:169], v[168:169], v[172:173], v[176:177] op_sel_hi:[1,0,1] neg_lo:[0,0,1] neg_hi:[0,0,1]
    v_pk_fma_f32 v[170:171], v[170:171], v[172:173], v[178:179] op_sel_hi:[1,0,1]
    v_pk_mul_f32 v[176:177], v[170:171], v[174:175] op_sel_hi:[1,0]
    v_pk_mul_f32 v[178:179], v[168:169], v[174:175] op_sel_hi:[1,0]
    v_cvt_pk_bf16_f32 v233, v168, v170
    v_cvt_pk_bf16_f32 v237, v169, v171
    v_pk_fma_f32 v[168:169], v[168:169], v[172:173], v[176:177] op_sel_hi:[1,0,1] neg_lo:[0,0,1] neg_hi:[0,0,1]
    v_pk_fma_f32 v[170:171], v[170:171], v[172:173], v[178:179] op_sel_hi:[1,0,1]
    v_pk_mul_f32 v[176:177], v[170:171], v[174:175] op_sel_hi:[1,0]
    v_pk_mul_f32 v[178:179], v[168:169], v[174:175] op_sel_hi:[1,0]
    v_cvt_pk_bf16_f32 v234, v168, v170
    v_cvt_pk_bf16_f32 v238, v169, v171
    v_pk_fma_f32 v[168:169], v[168:169], v[172:173], v[176:177] op_sel_hi:[1,0,1] neg_lo:[0,0,1] neg_hi:[0,0,1]
    v_pk_fma_f32 v[170:171], v[170:171], v[172:173], v[178:179] op_sel_hi:[1,0,1]
    v_pk_mul_f32 v[176:177], v[170:171], v[174:175] op_sel_hi:[1,0]
    v_pk_mul_f32 v[178:179], v[168:169], v[174:175] op_sel_hi:[1,0]
    v_cvt_pk_bf16_f32 v235, v168, v170
    v_cvt_pk_bf16_f32 v239, v169, v171
    v_pk_fma_f32 v[168:169], v[168:169], v[172:173], v[176:177] op_sel_hi:[1,0,1] neg_lo:[0,0,1] neg_hi:[0,0,1]
    v_pk_fma_f32 v[170:171], v[170:171], v[172:173], v[178:179] op_sel_hi:[1,0,1]
    v_pk_mul_f32 v[176:177], v[170:171], v[174:175] op_sel_hi:[1,0]
    v_pk_mul_f32 v[178:179], v[168:169], v[174:175] op_sel_hi:[1,0]
    v_cvt_pk_bf16_f32 v240, v168, v170
    v_cvt_pk_bf16_f32 v244, v169, v171
    v_pk_fma_f32 v[168:169], v[168:169], v[172:173], v[176:177] op_sel_hi:[1,0,1] neg_lo:[0,0,1] neg_hi:[0,0,1]
    v_pk_fma_f32 v[170:171], v[170:171], v[172:173], v[178:179] op_sel_hi:[1,0,1]
    v_pk_mul_f32 v[176:177], v[170:171], v[174:175] op_sel_hi:[1,0]
    v_pk_mul_f32 v[178:179], v[168:169], v[174:175] op_sel_hi:[1,0]
    v_cvt_pk_bf16_f32 v241, v168, v170
    v_cvt_pk_bf16_f32 v245, v169, v171
    v_pk_fma_f32 v[168:169], v[168:169], v[172:173], v[176:177] op_sel_hi:[1,0,1] neg_lo:[0,0,1] neg_hi:[0,0,1]
    v_pk_fma_f32 v[170:171], v[170:171], v[172:173], v[178:179] op_sel_hi:[1,0,1]
    v_pk_mul_f32 v[176:177], v[170:171], v[174:175] op_sel_hi:[1,0]
    v_pk_mul_f32 v[178:179], v[168:169], v[174:175] op_sel_hi:[1,0]
    v_cvt_pk_bf16_f32 v242, v168, v170
    v_cvt_pk_bf16_f32 v246, v169, v171
    v_pk_fma_f32 v[168:169], v[168:169], v[172:173], v[176:177] op_sel_hi:[1,0,1] neg_lo:[0,0,1] neg_hi:[0,0,1]
    v_pk_fma_f32 v[170:171], v[170:171], v[172:173], v[178:179] op_sel_hi:[1,0,1]
    v_cvt_pk_bf16_f32 v243, v168, v170
    v_cvt_pk_bf16_f32 v247, v169, v171
    s_cmp_lg_u32 s3, 4
    s_cbranch_scc1 L_GO
    s_mov_b32 s71, 0
    s_mov_b64 exec, 31
L_POLL:
    v_mov_b32 v15, 0
    buffer_atomic_or v15, v21, s[36:39], s60 offen sc0 sc1
    s_waitcnt vmcnt(1)
    v_or_b32 v188, v1, v192
    v_cmp_ne_u32 vcc, 65535, v188
    s_cbranch_vccz L_POLLED
    s_mov_b64 exec, vcc
    v_mov_b32 v1, 0
    buffer_atomic_or v1, v21, s[36:39], s60 offen sc0 sc1
    s_waitcnt vmcnt(1)
    v_or_b32 v188, v15, v192
    v_cmp_ne_u32 vcc, 65535, v188
    s_cbranch_vccz L_POLLED
    s_mov_b64 exec, vcc
    s_add_u32 s71, s71, 1
    s_cmp_gt_u32 s71, 200000
    s_cbranch_scc0 L_POLL
L_POLLED:
    s_mov_b64 exec, -1
    s_branch L_GO2
L_GO:
    s_waitcnt vmcnt(0)
L_GO2:
    s_waitcnt lgkmcnt(0)
    s_barrier
    s_cmp_eq_u32 s56, 0
    s_cbranch_scc0 L_Y
    s_add_u32 m0, s61, 0
    s_nop 0
    buffer_load_dwordx4 v10, s[36:39], s62 offen offset:0 sc1 lds
    buffer_load_dwordx4 v11, s[36:39], s62 offen offset:1024 sc1 lds
    buffer_load_dwordx4 v12, s[36:39], s62 offen offset:2048 sc1 lds
    buffer_load_dwordx4 v13, s[36:39], s62 offen offset:3072 sc1 lds
    s_add_u32 m0, m0, 4096
    s_nop 0
    buffer_load_dwordx4 v14, s[36:39], s62 offen offset:0 sc1 lds
    s_add_u32 m0, s61, 5120
    s_nop 0
    buffer_load_dwordx4 v10, s[36:39], s63 offen offset:0 sc1 lds
    buffer_load_dwordx4 v11, s[36:39], s63 offen offset:1024 sc1 lds
    buffer_load_dwordx4 v12, s[36:39], s63 offen offset:2048 sc1 lds
    buffer_load_dwordx4 v13, s[36:39], s63 offen offset:3072 sc1 lds
    s_add_u32 m0, m0, 4096
    s_nop 0
    buffer_load_dwordx4 v14, s[36:39], s63 offen offset:0 sc1 lds
    v_pk_mov_b32 v[168:169], 0, 0
    v_pk_mov_b32 v[170:171], 0, 0
    v_pk_mov_b32 v[172:173], 0, 0
    v_pk_mov_b32 v[174:175], 0, 0
    v_pk_mov_b32 v[176:177], 0, 0
    v_pk_mov_b32 v[178:179], 0, 0
    v_pk_mov_b32 v[180:181], 0, 0
    v_pk_mov_b32 v[182:183], 0, 0
    v_pk_mov_b32 v[184:185], 0, 0
    v_pk_mov_b32 v[186:187], 0, 0
    s_branch L_NOY
L_Y:
    s_setprio 0
    ds_read_b32 v24, v7
    ds_read_b128 v[188:191], v23 offset:0
    ds_read_b128 v[192:195], v23 offset:128
    ds_read_b128 v[196:199], v23 offset:256
    ds_read_b128 v[200:203], v23 offset:384
    ds_read_b128 v[204:207], v23 offset:512
    ds_read_b128 v[228:231], v23 offset:1280
    ds_read_b128 v[16:19], v23 offset:1408
    s_waitcnt lgkmcnt(6)
    v_mfma_f32_16x16x32_bf16 v[168:171], v[188:191], v[232:235], 0
    ds_read_b128 v[188:191], v23 offset:1536
    s_waitcnt lgkmcnt(6)
    v_mfma_f32_16x16x32_bf16 v[172:175], v[192:195], v[232:235], 0
    ds_read_b128 v[192:195], v23 offset:1664
    s_waitcnt lgkmcnt(6)
    v_mfma_f32_16x16x32_bf16 v[176:179], v[196:199], v[232:235], 0
    ds_read_b128 v[196:199], v23 offset:1792
    s_waitcnt lgkmcnt(6)
    v_mfma_f32_16x16x32_bf16 v[180:183], v[200:203], v[232:235], 0
    ds_read_b128 v[200:203], v23 offset:2560
    s_waitcnt lgkmcnt(6)
    v_mfma_f32_16x16x32_bf16 v[184:187], v[204:207], v[232:235], 0
    ds_read_b128 v[204:207], v23 offset:2688
    s_waitcnt lgkmcnt(6)
    v_mfma_f32_16x16x32_bf16 v[168:171], v[228:231], v[236:239], v[168:171]
    ds_read_b128 v[228:231], v23 offset:2816
    s_waitcnt lgkmcnt(6)
    v_mfma_f32_16x16x32_bf16 v[172:175], v[16:19], v[236:239], v[172:175]
    ds_read_b128 v[16:19], v23 offset:2944
    s_waitcnt lgkmcnt(6)
    v_mfma_f32_16x16x32_bf16 v[176:179], v[188:191], v[236:239], v[176:179]
    ds_read_b128 v[188:191], v23 offset:3072
    s_waitcnt lgkmcnt(6)
    v_mfma_f32_16x16x32_bf16 v[180:183], v[192:195], v[236:239], v[180:183]
    ds_read_b128 v[192:195], v23 offset:3840
    s_waitcnt lgkmcnt(6)
    v_mfma_f32_16x16x32_bf16 v[184:187], v[196:199], v[236:239], v[184:187]
    ds_read_b128 v[196:199], v23 offset:3968
    s_waitcnt lgkmcnt(6)
    v_mfma_f32_16x16x32_bf16 v[168:171], v[200:203], v[240:243], v[168:171]
    ds_read_b128 v[200:203], v23 offset:4096
    s_waitcnt lgkmcnt(6)
    v_mfma_f32_16x16x32_bf16 v[172:175], v[204:207], v[240:243], v[172:175]
    ds_read_b128 v[204:207], v23 offset:4224
    s_waitcnt lgkmcnt(6)
    v_mfma_f32_16x16x32_bf16 v[176:179], v[228:231], v[240:243], v[176:179]
    ds_read_b128 v[228:231], v23 offset:4352
    s_waitcnt lgkmcnt(6)
    v_mfma_f32_16x16x32_bf16 v[180:183], v[16:19], v[240:243], v[180:183]
    v_min_f32 v24, 0x41f00000, v24
    s_waitcnt lgkmcnt(5)
    v_mfma_f32_16x16x32_bf16 v[184:187], v[188:191], v[240:243], v[184:187]
    v_mul_f32 v24, 0x3fb8aa3b, v24
    s_waitcnt lgkmcnt(4)
    v_mfma_f32_16x16x32_bf16 v[168:171], v[192:195], v[244:247], v[168:171]
    v_exp_f32 v24, v24
    s_waitcnt lgkmcnt(3)
    v_mfma_f32_16x16x32_bf16 v[172:175], v[196:199], v[244:247], v[172:175]
    s_waitcnt lgkmcnt(2)
    v_mfma_f32_16x16x32_bf16 v[176:179], v[200:203], v[244:247], v[176:179]
    s_waitcnt lgkmcnt(1)
    v_mfma_f32_16x16x32_bf16 v[180:183], v[204:207], v[244:247], v[180:183]
    s_waitcnt lgkmcnt(0)
    v_mfma_f32_16x16x32_bf16 v[184:187], v[228:231], v[244:247], v[184:187]
    v_pk_mul_f32 v[168:169], v[168:169], v[24:25] op_sel_hi:[1,0]
    v_pk_mul_f32 v[170:171], v[170:171], v[24:25] op_sel_hi:[1,0]
    v_pk_mul_f32 v[172:173], v[172:173], v[24:25] op_sel_hi:[1,0]
    v_pk_mul_f32 v[174:175], v[174:175], v[24:25] op_sel_hi:[1,0]
    v_pk_mul_f32 v[176:177], v[176:177], v[24:25] op_sel_hi:[1,0]
    v_pk_mul_f32 v[178:179], v[178:179], v[24:25] op_sel_hi:[1,0]
    v_pk_mul_f32 v[180:181], v[180:181], v[24:25] op_sel_hi:[1,0]
    v_pk_mul_f32 v[182:183], v[182:183], v[24:25] op_sel_hi:[1,0]
    v_pk_mul_f32 v[184:185], v[184:185], v[24:25] op_sel_hi:[1,0]
    v_pk_mul_f32 v[186:187], v[186:187], v[24:25] op_sel_hi:[1,0]
    s_add_u32 m0, s61, 0
    s_nop 0
    buffer_load_dwordx4 v10, s[36:39], s62 offen offset:0 sc1 lds
    buffer_load_dwordx4 v11, s[36:39], s62 offen offset:1024 sc1 lds
    buffer_load_dwordx4 v12, s[36:39], s62 offen offset:2048 sc1 lds
    buffer_load_dwordx4 v13, s[36:39], s62 offen offset:3072 sc1 lds
    s_add_u32 m0, m0, 4096
    s_nop 0
    buffer_load_dwordx4 v14, s[36:39], s62 offen offset:0 sc1 lds
    s_add_u32 m0, s61, 5120
    s_nop 0
    buffer_load_dwordx4 v10, s[36:39], s63 offen offset:0 sc1 lds
    buffer_load_dwordx4 v11, s[36:39], s63 offen offset:1024 sc1 lds
    buffer_load_dwordx4 v12, s[36:39], s63 offen offset:2048 sc1 lds
    buffer_load_dwordx4 v13, s[36:39], s63 offen offset:3072 sc1 lds
    s_add_u32 m0, m0, 4096
    s_nop 0
    buffer_load_dwordx4 v14, s[36:39], s63 offen offset:0 sc1 lds
    s_setprio 1
L_NOY:
    ds_read_b32 v248, v249
    ds_read_b32 v250, v251
    s_mov_b32 s28, s22
    s_mov_b32 s29, s23
    s_mov_b32 s30, 2621440
    s_mov_b32 s31, 0x20000
    s_waitcnt vmcnt(5)
    ds_read_b128 v[188:191], v20 offset:0
    ds_read_b128 v[192:195], v20 offset:32
    ds_read_b128 v[196:199], v20 offset:64
    ds_read_b128 v[200:203], v20 offset:96
    ds_read_b128 v[204:207], v20 offset:128
    s_waitcnt lgkmcnt(4)
    v_mfma_f32_16x16x32_bf16 v[168:171], v[28:31], v[188:191], v[168:171]
    v_mfma_f32_16x16x32_bf16 v[172:175], v[32:35], v[188:191], v[172:175]
    v_mfma_f32_16x16x32_bf16 v[176:179], v[36:39], v[188:191], v[176:179]
    v_mfma_f32_16x16x32_bf16 v[180:183], v[40:43], v[188:191], v[180:183]
    v_mfma_f32_16x16x32_bf16 v[184:187], v[44:47], v[188:191], v[184:187]
    s_waitcnt lgkmcnt(0)
    v_mfma_f32_16x16x32_bf16 v[168:171], v[48:51], v[192:195], v[168:171]
    ds_read_b64_tr_b16 v[28:29], v9 offset:5120
    ds_read_b64_tr_b16 v[30:31], v9 offset:6400
    v_mfma_f32_16x16x32_bf16 v[172:175], v[52:55], v[192:195], v[172:175]
    ds_read_b64_tr_b16 v[32:33], v9 offset:5152
    ds_read_b64_tr_b16 v[34:35], v9 offset:6432
    v_mfma_f32_16x16x32_bf16 v[176:179], v[56:59], v[192:195], v[176:179]
    ds_read_b64_tr_b16 v[36:37], v9 offset:5184
    ds_read_b64_tr_b16 v[38:39], v9 offset:6464
    v_mfma_f32_16x16x32_bf16 v[180:183], v[60:63], v[192:195], v[180:183]
    ds_read_b64_tr_b16 v[40:41], v9 offset:5216
    ds_read_b64_tr_b16 v[42:43], v9 offset:6496
    v_mfma_f32_16x16x32_bf16 v[184:187], v[64:67], v[192:195], v[184:187]
    ds_read_b64_tr_b16 v[44:45], v9 offset:5248
    ds_read_b64_tr_b16 v[46:47], v9 offset:6528
    v_mfma_f32_16x16x32_bf16 v[168:171], v[68:71], v[196:199], v[168:171]
    ds_read_b64_tr_b16 v[48:49], v9 offset:10240
    v_mfma_f32_16x16x32_bf16 v[172:175], v[72:75], v[196:199], v[172:175]
    ds_read_b64_tr_b16 v[50:51], v9 offset:11520
    v_mfma_f32_16x16x32_bf16 v[176:179], v[76:79], v[196:199], v[176:179]
    ds_read_b64_tr_b16 v[52:53], v9 offset:10272
    v_mfma_f32_16x16x32_bf16 v[180:183], v[80:83], v[196:199], v[180:183]
    ds_read_b64_tr_b16 v[54:55], v9 offset:11552
    v_mfma_f32_16x16x32_bf16 v[184:187], v[84:87], v[196:199], v[184:187]
    ds_read_b64_tr_b16 v[56:57], v9 offset:10304
    v_mfma_f32_16x16x32_bf16 v[168:171], v[88:91], v[200:203], v[168:171]
    ds_read_b64_tr_b16 v[58:59], v9 offset:11584
    v_mfma_f32_16x16x32_bf16 v[172:175], v[92:95], v[200:203], v[172:175]
    ds_read_b64_tr_b16 v[60:61], v9 offset:10336
    v_mfma_f32_16x16x32_bf16 v[176:179], v[96:99], v[200:203], v[176:179]
    ds_read_b64_tr_b16 v[62:63], v9 offset:11616
    v_mfma_f32_16x16x32_bf16 v[180:183], v[100:103], v[200:203], v[180:183]
    ds_read_b64_tr_b16 v[64:65], v9 offset:10368
    v_mfma_f32_16x16x32_bf16 v[184:187], v[104:107], v[200:203], v[184:187]
    ds_read_b64_tr_b16 v[66:67], v9 offset:11648
    s_waitcnt vmcnt(0) lgkmcnt(8)
    ds_read_b128 v[68:71], v20 offset:5120
    ds_read_b128 v[72:75], v20 offset:5152
    ds_read_b128 v[76:79], v20 offset:5184
    ds_read_b128 v[80:83], v20 offset:5216
    ds_read_b128 v[84:87], v20 offset:5248
    v_mfma_f32_16x16x32_bf16 v[168:171], v[108:111], v[204:207], v[168:171]
    v_mfma_f32_16x16x32_bf16 v[172:175], v[112:115], v[204:207], v[172:175]
    v_mfma_f32_16x16x32_bf16 v[176:179], v[116:119], v[204:207], v[176:179]
    v_mfma_f32_16x16x32_bf16 v[180:183], v[120:123], v[204:207], v[180:183]
    v_mfma_f32_16x16x32_bf16 v[184:187], v[124:127], v[204:207], v[184:187]
    s_waitcnt lgkmcnt(0)
    v_mfma_f32_16x16x32_bf16 v[168:171], v[128:131], v[68:71], v[168:171]
    v_min_f32 v248, 0x41f00000, v248
    v_mfma_f32_16x16x32_bf16 v[172:175], v[132:135], v[68:71], v[172:175]
    v_mul_f32 v248, 0x3fb8aa3b, v248
    v_mfma_f32_16x16x32_bf16 v[176:179], v[136:139], v[68:71], v[176:179]
    v_exp_f32 v248, v248
    v_mfma_f32_16x16x32_bf16 v[180:183], v[140:143], v[68:71], v[180:183]
    v_add_f32 v248, 1.0, v248
    v_mfma_f32_16x16x32_bf16 v[184:187], v[144:147], v[68:71], v[184:187]
    v_rcp_f32 v248, v248
    v_mfma_f32_16x16x32_bf16 v[168:171], v[148:151], v[72:75], v[168:171]
    v_min_f32 v250, 0x41f00000, v250
    v_mfma_f32_16x16x32_bf16 v[172:175], v[152:155], v[72:75], v[172:175]
    v_mul_f32 v250, 0x3fb8aa3b, v250
    v_mfma_f32_16x16x32_bf16 v[176:179], v[156:159], v[72:75], v[176:179]
    v_exp_f32 v250, v250
    v_mfma_f32_16x16x32_bf16 v[180:183], v[160:163], v[72:75], v[180:183]
    v_add_f32 v250, 1.0, v250
    v_mfma_f32_16x16x32_bf16 v[184:187], v[164:167], v[72:75], v[184:187]
    v_rcp_f32 v250, v250
    v_mfma_f32_16x16x32_bf16 v[168:171], v[208:211], v[76:79], v[168:171]
    v_mfma_f32_16x16x32_bf16 v[172:175], v[212:215], v[76:79], v[172:175]
    v_mfma_f32_16x16x32_bf16 v[176:179], v[216:219], v[76:79], v[176:179]
    v_mfma_f32_16x16x32_bf16 v[180:183], v[220:223], v[76:79], v[180:183]
    v_mfma_f32_16x16x32_bf16 v[184:187], v[224:227], v[76:79], v[184:187]
    v_mfma_f32_16x16x32_bf16 v[168:171], v[28:31], v[80:83], v[168:171]
    v_mfma_f32_16x16x32_bf16 v[172:175], v[32:35], v[80:83], v[172:175]
    v_mfma_f32_16x16x32_bf16 v[176:179], v[36:39], v[80:83], v[176:179]
    v_mfma_f32_16x16x32_bf16 v[180:183], v[40:43], v[80:83], v[180:183]
    v_mfma_f32_16x16x32_bf16 v[184:187], v[44:47], v[80:83], v[184:187]
    v_mfma_f32_16x16x32_bf16 v[168:171], v[48:51], v[84:87], v[168:171]
    v_mfma_f32_16x16x32_bf16 v[172:175], v[52:55], v[84:87], v[172:175]
    v_mfma_f32_16x16x32_bf16 v[176:179], v[56:59], v[84:87], v[176:179]
    v_mfma_f32_16x16x32_bf16 v[180:183], v[60:63], v[84:87], v[180:183]
    v_mfma_f32_16x16x32_bf16 v[184:187], v[64:67], v[84:87], v[184:187]
    s_nop 3
    ds_write_b128 v22, v[168:171] offset:0
    ds_write_b128 v22, v[172:175] offset:64
    ds_write_b128 v22, v[176:179] offset:128
    ds_write_b128 v22, v[180:183] offset:192
    ds_write_b128 v22, v[184:187] offset:256
    s_waitcnt lgkmcnt(0)
    s_barrier
    ds_read_b128 v[28:31], v252
    ds_read_b128 v[32:35], v252 offset:16
    ds_read_b128 v[36:39], v253 offset:40960
    ds_read_b128 v[40:43], v253 offset:40976
    s_cmp_ge_u32 s3, 2
    s_cbranch_scc1 L_F1
    ds_read_b128 v[52:55], v254
    ds_read_b128 v[56:59], v254 offset:16
    ds_read_b128 v[60:63], v255 offset:40960
    ds_read_b128 v[64:67], v255 offset:40976
    s_waitcnt lgkmcnt(4)
    v_pk_add_f32 v[28:29], v[28:29], v[36:37]
    v_pk_add_f32 v[30:31], v[30:31], v[38:39]
    v_pk_add_f32 v[32:33], v[32:33], v[40:41]
    v_pk_add_f32 v[34:35], v[34:35], v[42:43]
    v_pk_mul_f32 v[28:29], v[28:29], v[248:249] op_sel_hi:[1,0]
    v_pk_mul_f32 v[30:31], v[30:31], v[248:249] op_sel_hi:[1,0]
    v_pk_mul_f32 v[32:33], v[32:33], v[248:249] op_sel_hi:[1,0]
    v_pk_mul_f32 v[34:35], v[34:35], v[248:249] op_sel_hi:[1,0]
    v_cvt_pk_bf16_f32 v36, v28, v29
    v_cvt_pk_bf16_f32 v37, v30, v31
    v_cvt_pk_bf16_f32 v38, v32, v33
    v_cvt_pk_bf16_f32 v39, v34, v35
    buffer_store_dwordx4 v[36:39], v26, s[28:31], 0 offen
    s_waitcnt lgkmcnt(0)
    v_pk_add_f32 v[52:53], v[52:53], v[60:61]
    v_pk_add_f32 v[54:55], v[54:55], v[62:63]
    v_pk_add_f32 v[56:57], v[56:57], v[64:65]
    v_pk_add_f32 v[58:59], v[58:59], v[66:67]
    v_pk_mul_f32 v[52:53], v[52:53], v[250:251] op_sel_hi:[1,0]
    v_pk_mul_f32 v[54:55], v[54:55], v[250:251] op_sel_hi:[1,0]
    v_pk_mul_f32 v[56:57], v[56:57], v[250:251] op_sel_hi:[1,0]
    v_pk_mul_f32 v[58:59], v[58:59], v[250:251] op_sel_hi:[1,0]
    v_cvt_pk_bf16_f32 v60, v52, v53
    v_cvt_pk_bf16_f32 v61, v54, v55
    v_cvt_pk_bf16_f32 v62, v56, v57
    v_cvt_pk_bf16_f32 v63, v58, v59
    buffer_store_dwordx4 v[60:63], v27, s[28:31], 0 offen
    s_branch L_F2
L_F1:
    s_waitcnt lgkmcnt(0)
    v_pk_add_f32 v[28:29], v[28:29], v[36:37]
    v_pk_add_f32 v[30:31], v[30:31], v[38:39]
    v_pk_add_f32 v[32:33], v[32:33], v[40:41]
    v_pk_add_f32 v[34:35], v[34:35], v[42:43]
    v_pk_mul_f32 v[28:29], v[28:29], v[248:249] op_sel_hi:[1,0]
    v_pk_mul_f32 v[30:31], v[30:31], v[248:249] op_sel_hi:[1,0]
    v_pk_mul_f32 v[32:33], v[32:33], v[248:249] op_sel_hi:[1,0]
    v_pk_mul_f32 v[34:35], v[34:35], v[248:249] op_sel_hi:[1,0]
    v_cvt_pk_bf16_f32 v36, v28, v29
    v_cvt_pk_bf16_f32 v37, v30, v31
    v_cvt_pk_bf16_f32 v38, v32, v33
    v_cvt_pk_bf16_f32 v39, v34, v35
    buffer_store_dwordx4 v[36:39], v26, s[28:31], 0 offen
L_F2:
L_END:
    s_endpgm

.section .rodata,"a"
.p2align 6
.amdhsa_kernel gated_mix__spectral_fnet__sliding_local_dilated__prompt_kernel
  .amdhsa_next_free_vgpr 256
  .amdhsa_next_free_sgpr 100
  .amdhsa_accum_offset 256
  .amdhsa_group_segment_fixed_size 0
  .amdhsa_kernarg_size 96
  .amdhsa_user_sgpr_count 2
  .amdhsa_user_sgpr_kernarg_segment_ptr 1
  .amdhsa_system_sgpr_workgroup_id_x 1
.end_amdhsa_kernel
```
